```python
import torch

def _softmax(x, axis=-1):
    return torch.softmax(x, dim=axis)

def _gelu(x):
    return torch.nn.functional.gelu(x, approximate='tanh')

def _silu(x):
    return torch.nn.functional.silu(x)

def _sigmoid(x):
    return torch.sigmoid(x)

def _layernorm(x, axis=-1, eps=1e-05):
    m = x.mean(dim=axis, keepdim=True)
    v = x.var(dim=axis, keepdim=True, unbiased=False)
    return (x - m) / torch.sqrt(v + eps)

def _scatter_add(tgt, idx, src, axis=0):
    return tgt.clone().index_add_(axis, idx, src)

def _segment_sum(src, seg, n):
    out = torch.zeros((n,) + src.shape[1:], dtype=src.dtype)
    return out.index_add_(0, seg, src)

def _pad(x, pw):
    flat = tuple((v for pair in reversed(pw) for v in pair))
    return torch.nn.functional.pad(x, flat)
kernel_name = 'adaLN_cond__linear_kernel_hedgehog__dense_activation_relu__prompt'

def setup_inputs():

    _w = lambda a: (lambda t: t.to(torch.bfloat16) if t.is_floating_point() else t)(torch.as_tensor(a))

    def _A_setup():
        B, S, D, H = (1, 2048, 512, 32)
        Dh = D // H
        return {'x': _w((lambda *s: torch.randn(*s, dtype=torch.bfloat16) * 0.05)(B, S, D)), 'wqkv': _w((lambda *s: torch.randn(*s, dtype=torch.bfloat16) * 0.4)(D, 3 * D)), 'w_phi': _w((lambda *s: torch.randn(*s, dtype=torch.bfloat16) * 0.4)(H, Dh, Dh) * Dh ** (-0.5)), 'wo': _w((lambda *s: torch.randn(*s, dtype=torch.bfloat16) * 0.05)(D, D))}
    _A_in = _A_setup()

    def _B_setup():
        B, S, D, Dff = (1, 2048, 512, 1376)
        return {'x': _w((lambda *s: torch.randn(*s, dtype=torch.bfloat16) * 0.05)(B, S, D)), 'w1': _w((lambda *s: torch.randn(*s, dtype=torch.bfloat16) * 0.05)(D, Dff)), 'w2': _w((lambda *s: torch.randn(*s, dtype=torch.bfloat16) * 0.05)(Dff, D))}
    _B_in = _B_setup()
    return {'A_x': _A_in['x'], 'A_wqkv': _A_in['wqkv'], 'A_w_phi': _A_in['w_phi'], 'A_wo': _A_in['wo'], 'B_x': _B_in['x'], 'B_w1': _B_in['w1'], 'B_w2': _B_in['w2'], 'c': _w((lambda *s: torch.randn(*s, dtype=torch.bfloat16) * 0.1)(1, 512) * 8.0), 'w_mod': _w((lambda *s: torch.randn(*s, dtype=torch.bfloat16) * 0.1)(512, 6 * 512) * 512 ** (-0.5) * 8.0)}

def reference(A_x, A_wqkv, A_w_phi, A_wo, B_x, B_w1, B_w2, c, w_mod):

    def _A_ref(x, wqkv, w_phi, wo):
        B, S, D = x.shape
        H = 32
        Dh = D // H
        qkv = (lambda x, *d: x.permute(*d))((x @ wqkv).reshape(B, S, 3, H, Dh), 2, 0, 3, 1, 4)
        q, k, v = (qkv[0], qkv[1], qkv[2])
        pq = torch.einsum('bhsd,hdf->bhsf', q, w_phi)
        pk = torch.einsum('bhsd,hdf->bhsf', k, w_phi)
        phi_q = torch.concatenate([_softmax(pq, axis=-1), _softmax(-pq, axis=-1)], axis=-1)
        phi_k = torch.concatenate([_softmax(pk, axis=-1), _softmax(-pk, axis=-1)], axis=-1)
        kv = torch.einsum('bhsf,bhsd->bhfd', phi_k, v)
        z = torch.einsum('bhsf->bhf', phi_k)
        num = torch.einsum('bhqf,bhfd->bhqd', phi_q, kv)
        den = torch.einsum('bhqf,bhf->bhq', phi_q, z)[..., None] + 1e-06
        o = num / den
        return (lambda x, *d: x.permute(*d))(o, 0, 2, 1, 3).reshape(B, S, D) @ wo

    def _B_ref(x, w1, w2):
        h = torch.einsum('bsd,df->bsf', x, w1)
        zero = torch.zeros_like(h)
        h = torch.maximum(h, zero)
        return torch.einsum('bsf,fd->bsd', h, w2)
    x = A_x
    mod = (_silu(c) @ w_mod).reshape(c.shape[0], 6, 1, -1)
    sa, ca, ga, sb, cb, gb = (mod[:, 0].clone(), mod[:, 1].clone(), mod[:, 2].clone(), mod[:, 3].clone(), mod[:, 4].clone(), mod[:, 5].clone())
    h = _layernorm(x, axis=-1) * (1 + ca) + sa
    x = x + ga * _A_ref(h, A_wqkv, A_w_phi, A_wo)
    h = _layernorm(x, axis=-1) * (1 + cb) + sb
    x = x + gb * _B_ref(h, B_w1, B_w2)
    return x
```

```asm
; @launch grid=(256,1,1) block=(256,1,1) lds=163840
.amdgcn_target "amdgcn-amd-amdhsa--gfx950"
.text
.globl adaLN_cond__linear_kernel_hedgehog__dense_activation_relu__prompt_kernel
.p2align 8
.type adaLN_cond__linear_kernel_hedgehog__dense_activation_relu__prompt_kernel,@function
adaLN_cond__linear_kernel_hedgehog__dense_activation_relu__prompt_kernel:
    s_load_dwordx16 s[4:19], s[0:1], 0
    s_load_dwordx8 s[20:27], s[0:1], 64
    s_cmp_ge_u32 s2, 256
    s_cbranch_scc0 L_go
    s_endpgm
L_go:
    s_getpc_b64 s[72:73]
L_pc:
    s_lshr_b32 s74, s2, 3
    s_lshl_b32 s74, s74, 10
    v_lshrrev_b32 v10, 5, v0
    v_lshl_add_u32 v10, v10, 7, s74
    v_min_u32 v10, L_last-L_pc, v10
    v_add_co_u32 v10, vcc, s72, v10
    v_mov_b32 v11, s73
    s_nop 0
    v_addc_co_u32 v11, vcc, 0, v11, vcc
    global_load_dword v12, v[10:11], off
    v_lshrrev_b32 v6, 6, v0
    v_and_b32 v0, 63, v0
    s_and_b32 s60, s2, 7
    v_readfirstlane_b32 s64, v6
    s_lshr_b32 s61, s2, 3
    s_lshr_b32 s62, s61, 4
    s_lshl_b32 s72, s60, 1
    s_add_u32 s62, s62, s72
    s_and_b32 s63, s61, 15
    v_lshlrev_b32 v1, 4, v0
    s_mov_b32 s69, 0x3fb8aa3b
    s_mov_b32 s70, 0x05040100
    s_mov_b32 s82, 0x07060302
    s_mov_b32 s71, 0xffff0000
    s_mov_b32 s67, 0x20000
    s_lshl_b32 s68, s64, 14
    s_getreg_b32 s83, hwreg(HW_REG_XCC_ID, 0, 4)
    s_and_b32 s72, s61, 6
    s_lshl_b32 s72, s72, 1
    s_add_u32 s72, s72, s64
    s_lshl_b32 s72, s72, 3
    v_lshrrev_b32 v6, 3, v0
    v_add_lshl_u32 v7, v6, s72, 3
    v_mul_u32_u24 v14, 0xc00, v7
    v_and_b32 v8, 7, v0
    v_lshl_add_u32 v14, v8, 4, v14
    s_and_b32 s89, s61, 1
    s_lshl_b32 s89, s89, 3
    s_add_u32 s89, s89, s60
    s_lshl_b32 s89, s89, 2
    s_lshl_b32 s88, s61, 2
    s_add_u32 s88, s88, s64
    v_lshrrev_b32 v6, 3, v0
    v_xor_b32 v8, v6, v0
    v_and_b32 v8, 7, v8
    v_lshlrev_b32 v8, 4, v8
    v_lshl_add_u32 v44, v6, 10, v8
    v_and_b32 v6, 7, v0
    v_lshl_add_u32 v6, v6, 7, v8
    v_add_u32 v45, s68, v6
    s_lshl_b32 s90, s62, 4
    s_add_u32 s90, s90, s63
    s_lshl_b32 s90, s90, 13
    s_lshl_b32 s74, s64, 8
    s_add_u32 s90, s90, s74
    v_lshrrev_b32 v6, 2, v0
    v_mul_u32_u24 v6, 0xc00, v6
    v_and_b32 v8, 3, v0
    v_lshl_add_u32 v239, v8, 4, v6
    s_bfe_u32 s74, s63, 0x20001
    s_xor_b32 s74, s74, s64
    s_mul_i32 s91, s74, 393216
    s_lshl_b32 s74, s63, 6
    s_add_u32 s91, s91, s74
    s_lshl_b32 s96, s64, 13
    s_waitcnt lgkmcnt(0)
    s_load_dword s65, s[26:27], 0
    s_mov_b32 s48, s20
    s_mov_b32 s49, s21
    s_mov_b32 s50, 0x300000
    s_mov_b32 s51, 0x00020000
    s_mov_b32 s28, s4
    s_mov_b32 s29, s5
    s_mov_b32 s30, 0x200000
    s_mov_b32 s31, 0x00020000
    s_cmp_ge_u32 s61, 8
    s_cbranch_scc1 L_nowm
    global_load_dwordx2 v[32:33], v7, s[18:19]
    s_lshl_b32 s78, s89, 5
    buffer_load_dwordx4 v[16:19], v14, s[48:51], s78 offen nt
    s_add_u32 s78, s78, 6144
    buffer_load_dwordx4 v[20:23], v14, s[48:51], s78 offen nt
    s_add_u32 s78, s78, 6144
    buffer_load_dwordx4 v[24:27], v14, s[48:51], s78 offen nt
    s_add_u32 s78, s78, 6144
    buffer_load_dwordx4 v[28:31], v14, s[48:51], s78 offen nt
    s_branch L_nox
L_nowm:
    s_add_u32 m0, s68, 0x400
    s_add_u32 s79, s90, 0x0
    buffer_load_dwordx4 v44, s[28:31], s79 offen nt lds
    s_add_u32 m0, s68, 0x800
    s_add_u32 s79, s90, 0x80
    buffer_load_dwordx4 v44, s[28:31], s79 offen nt lds
L_nox:
    s_mov_b32 s32, s6
    s_mov_b32 s33, s7
    s_mov_b32 s34, 0x180000
    s_mov_b32 s35, 0x00020000
    s_mov_b32 s36, s10
    s_mov_b32 s37, s11
    s_mov_b32 s38, 0x80000
    s_mov_b32 s39, 0x00020000
    s_mov_b32 s44, s16
    s_mov_b32 s45, s17
    s_mov_b32 s46, 0x158000
    s_mov_b32 s47, 0x00020000
    s_mov_b32 s40, s14
    s_mov_b32 s41, s15
    s_mov_b32 s42, 0x158000
    s_mov_b32 s43, 0x00020000
    s_mov_b32 s52, s26
    s_mov_b32 s53, s27
    s_mov_b32 s54, 0x200000
    s_mov_b32 s55, 0x00020000
    s_lshl_b32 s72, s62, 19
    s_add_u32 s72, s72, 0x200000
    s_add_u32 s56, s26, s72
    s_addc_u32 s57, s27, 0
    s_mov_b32 s58, 0x80000
    s_mov_b32 s59, 0x00020000
    v_lshrrev_b32 v4, 3, v0
    v_lshlrev_b32 v4, 10, v4
    v_bfe_u32 v6, v0, 4, 1
    v_lshlrev_b32 v6, 2, v6
    v_and_b32 v7, 7, v0
    v_xor_b32 v6, v6, v7
    v_lshl_add_u32 v4, v6, 4, v4
    s_and_b32 s72, s63, 7
    s_lshl_b32 s72, s72, 7
    s_lshl_b32 s12, s64, 17
    s_add_u32 s12, s12, s72
    s_mul_i32 s13, s64, 360448
    s_add_u32 s13, s13, s72
    v_lshrrev_b32 v6, 5, v0
    v_bfe_u32 v7, v0, 2, 2
    v_lshl_add_u32 v6, v6, 2, v7
    v_lshlrev_b32 v2, 7, v6
    v_bfe_u32 v6, v0, 3, 1
    s_lshr_b32 s72, s64, 1
    v_xor_b32 v6, s72, v6
    v_lshl_add_u32 v2, v6, 6, v2
    v_bfe_u32 v6, v0, 4, 1
    v_lshlrev_b32 v6, 5, v6
    v_and_b32 v7, 3, v0
    v_lshl_add_u32 v10, v7, 3, v6
    v_add3_u32 v2, v2, v10, s68
    v_xor_b32 v3, 64, v2
    s_cmp_ge_u32 s61, 8
    s_cbranch_scc1 L_nc
    s_waitcnt vmcnt(4)
    v_lshlrev_b32 v48, 16, v32
    v_and_b32 v49, s71, v32
    v_lshlrev_b32 v50, 16, v33
    v_and_b32 v51, s71, v33
    v_mul_f32 v52, 0xbfb8aa3b, v48
    v_mul_f32 v53, 0xbfb8aa3b, v49
    v_mul_f32 v54, 0xbfb8aa3b, v50
    v_mul_f32 v55, 0xbfb8aa3b, v51
    v_exp_f32 v52, v52
    v_exp_f32 v53, v53
    v_exp_f32 v54, v54
    v_exp_f32 v55, v55
    v_add_f32 v52, 1.0, v52
    v_add_f32 v53, 1.0, v53
    v_add_f32 v54, 1.0, v54
    v_add_f32 v55, 1.0, v55
    v_rcp_f32 v52, v52
    v_rcp_f32 v53, v53
    v_rcp_f32 v54, v54
    v_rcp_f32 v55, v55
    v_mul_f32 v48, v48, v52
    v_mul_f32 v49, v49, v53
    v_mul_f32 v50, v50, v54
    v_mul_f32 v51, v51, v55
    v_cvt_pk_bf16_f32 v56, v48, 0
    v_cvt_pk_bf16_f32 v60, 0, v48
    v_cvt_pk_bf16_f32 v57, v49, 0
    v_cvt_pk_bf16_f32 v61, 0, v49
    v_cvt_pk_bf16_f32 v58, v50, 0
    v_cvt_pk_bf16_f32 v62, 0, v50
    v_cvt_pk_bf16_f32 v59, v51, 0
    v_cvt_pk_bf16_f32 v63, 0, v51
    s_waitcnt vmcnt(3)
    v_dot2_f32_bf16 v48, v16, v56, 0
    v_dot2_f32_bf16 v49, v16, v60, 0
    v_dot2_f32_bf16 v50, v17, v56, 0
    v_dot2_f32_bf16 v51, v17, v60, 0
    v_dot2_f32_bf16 v52, v18, v56, 0
    v_dot2_f32_bf16 v53, v18, v60, 0
    v_dot2_f32_bf16 v54, v19, v56, 0
    v_dot2_f32_bf16 v55, v19, v60, 0
    s_waitcnt vmcnt(2)
    v_dot2_f32_bf16 v48, v20, v57, v48
    v_dot2_f32_bf16 v49, v20, v61, v49
    v_dot2_f32_bf16 v50, v21, v57, v50
    v_dot2_f32_bf16 v51, v21, v61, v51
    v_dot2_f32_bf16 v52, v22, v57, v52
    v_dot2_f32_bf16 v53, v22, v61, v53
    v_dot2_f32_bf16 v54, v23, v57, v54
    v_dot2_f32_bf16 v55, v23, v61, v55
    s_waitcnt vmcnt(1)
    v_dot2_f32_bf16 v48, v24, v58, v48
    v_dot2_f32_bf16 v49, v24, v62, v49
    v_dot2_f32_bf16 v50, v25, v58, v50
    v_dot2_f32_bf16 v51, v25, v62, v51
    v_dot2_f32_bf16 v52, v26, v58, v52
    v_dot2_f32_bf16 v53, v26, v62, v53
    v_dot2_f32_bf16 v54, v27, v58, v54
    v_dot2_f32_bf16 v55, v27, v62, v55
    s_waitcnt vmcnt(0)
    v_dot2_f32_bf16 v48, v28, v59, v48
    v_dot2_f32_bf16 v49, v28, v63, v49
    v_dot2_f32_bf16 v50, v29, v59, v50
    v_dot2_f32_bf16 v51, v29, v63, v51
    v_dot2_f32_bf16 v52, v30, v59, v52
    v_dot2_f32_bf16 v53, v30, v63, v53
    v_dot2_f32_bf16 v54, v31, v59, v54
    v_dot2_f32_bf16 v55, v31, v63, v55
    s_add_u32 m0, s68, 0x400
    s_add_u32 s79, s90, 0x0
    buffer_load_dwordx4 v44, s[28:31], s79 offen nt lds
    s_add_u32 m0, s68, 0x800
    s_add_u32 s79, s90, 0x80
    buffer_load_dwordx4 v44, s[28:31], s79 offen nt lds
    v_and_b32 v6, 7, v0
    v_lshlrev_b32 v6, 5, v6
    v_and_b32 v7, 16, v0
    v_add3_u32 v6, v6, v7, s68
    v_lshrrev_b32 v7, 5, v0
    v_lshl_add_u32 v6, v7, 3, v6
    v_add_f32_dpp v48, v48, v48 row_ror:8 row_mask:0xf bank_mask:0xf
    v_add_f32_dpp v49, v49, v49 row_ror:8 row_mask:0xf bank_mask:0xf
    v_add_f32_dpp v50, v50, v50 row_ror:8 row_mask:0xf bank_mask:0xf
    v_add_f32_dpp v51, v51, v51 row_ror:8 row_mask:0xf bank_mask:0xf
    v_add_f32_dpp v52, v52, v52 row_ror:8 row_mask:0xf bank_mask:0xf
    v_add_f32_dpp v53, v53, v53 row_ror:8 row_mask:0xf bank_mask:0xf
    v_add_f32_dpp v54, v54, v54 row_ror:8 row_mask:0xf bank_mask:0xf
    v_add_f32_dpp v55, v55, v55 row_ror:8 row_mask:0xf bank_mask:0xf
    v_permlane16_swap_b32 v48, v52
    v_permlane16_swap_b32 v49, v53
    v_permlane16_swap_b32 v50, v54
    v_permlane16_swap_b32 v51, v55
    v_add_f32 v48, v48, v52
    v_add_f32 v49, v49, v53
    v_add_f32 v50, v50, v54
    v_add_f32 v51, v51, v55
    s_nop 0
    v_permlane32_swap_b32 v48, v50
    v_permlane32_swap_b32 v49, v51
    v_add_f32 v48, v48, v50
    v_add_f32 v49, v49, v51
    ds_write_b64 v6, v[48:49] offset:15360
    s_waitcnt lgkmcnt(0)
    s_barrier
    s_waitcnt lgkmcnt(0)
    s_add_u32 s65, s65, 1
    s_cmp_lg_u32 s64, 1
    s_cbranch_scc1 nohello_1
    v_mov_b32 v6, s65
    v_mov_b32 v7, s83
    v_lshlrev_b32 v8, 3, v0
    s_lshl_b32 s72, s2, 7
    s_add_u32 s72, s72, 0x1000
    s_mov_b64 exec, 0xffff
    buffer_store_dwordx2 v[6:7], v8, s[52:55], s72 offen sc1
    s_mov_b64 exec, -1
nohello_1:
    s_cmp_lg_u32 s64, 0
    s_cbranch_scc1 L_nopub
    v_lshlrev_b32 v7, 2, v0
    ds_read_b32 v48, v7 offset:15360
    ds_read_b32 v49, v7 offset:31744
    ds_read_b32 v50, v7 offset:48128
    ds_read_b32 v51, v7 offset:64512
    s_and_b32 s76, s61, 1
    s_lshl_b32 s76, s76, 2
    s_lshr_b32 s77, s61, 1
    s_add_u32 s76, s76, s77
    s_lshl_b32 s76, s76, 3
    s_add_u32 s76, s76, s60
    s_lshl_b32 s76, s76, 8
    s_add_u32 s76, s76, 0x10000
    v_lshlrev_b32 v9, 3, v0
    v_lshrrev_b32 v9, v9, s65
    s_movk_i32 s77, 0xff
    s_waitcnt lgkmcnt(0)
    v_add_f32 v48, v48, v49
    v_add_f32 v50, v50, v51
    v_add_f32 v48, v48, v50
    v_bfi_b32 v48, s77, v9, v48
    buffer_store_dword v48, v7, s[52:55], s76 offen sc1
L_nopub:
    v_and_b32 v6, 31, v0
    s_lshl_b32 s72, s64, 3
    v_xor_b32 v6, s72, v6
    v_lshrrev_b32 v7, 5, v0
    v_lshlrev_b32 v7, 2, v7
    v_sub_u32 v6, v6, v7
    v_mov_b32 v7, 0x3f80
    v_mov_b32 v8, 0x3f800000
    v_cmp_eq_u32 vcc, 0, v6
    s_nop 1
    v_cndmask_b32 v240, 0, v7, vcc
    v_cmp_eq_u32 vcc, 1, v6
    s_nop 1
    v_cndmask_b32 v240, v240, v8, vcc
    v_cmp_eq_u32 vcc, 2, v6
    s_nop 1
    v_cndmask_b32 v241, 0, v7, vcc
    v_cmp_eq_u32 vcc, 3, v6
    s_nop 1
    v_cndmask_b32 v241, v241, v8, vcc
    v_cmp_eq_u32 vcc, 8, v6
    s_nop 1
    v_cndmask_b32 v242, 0, v7, vcc
    v_cmp_eq_u32 vcc, 9, v6
    s_nop 1
    v_cndmask_b32 v242, v242, v8, vcc
    v_cmp_eq_u32 vcc, 10, v6
    s_nop 1
    v_cndmask_b32 v243, 0, v7, vcc
    v_cmp_eq_u32 vcc, 11, v6
    s_nop 1
    v_cndmask_b32 v243, v243, v8, vcc
    v_cmp_eq_u32 vcc, 16, v6
    s_nop 1
    v_cndmask_b32 v244, 0, v7, vcc
    v_cmp_eq_u32 vcc, 17, v6
    s_nop 1
    v_cndmask_b32 v244, v244, v8, vcc
    v_cmp_eq_u32 vcc, 18, v6
    s_nop 1
    v_cndmask_b32 v245, 0, v7, vcc
    v_cmp_eq_u32 vcc, 19, v6
    s_nop 1
    v_cndmask_b32 v245, v245, v8, vcc
    v_cmp_eq_u32 vcc, 24, v6
    s_nop 1
    v_cndmask_b32 v246, 0, v7, vcc
    v_cmp_eq_u32 vcc, 25, v6
    s_nop 1
    v_cndmask_b32 v246, v246, v8, vcc
    v_cmp_eq_u32 vcc, 26, v6
    s_nop 1
    v_cndmask_b32 v247, 0, v7, vcc
    v_cmp_eq_u32 vcc, 27, v6
    s_nop 1
    v_cndmask_b32 v247, v247, v8, vcc
    s_cmp_lt_u32 s64, 2
    s_waitcnt vmcnt(1)
    s_cbranch_scc1 L_mrg
    s_waitcnt vmcnt(0)
    s_branch L_mrg
L_nc:
    s_cmp_ge_u32 s61, 16
    s_cselect_b32 s78, 1, 0xffff
    s_sub_u32 s79, s90, 0x10000
    v_and_b32 v9, 7, v0
    v_lshlrev_b32 v9, 10, v9
    v_bfe_u32 v238, v0, 3, 1
    v_lshl_add_u32 v9, v238, 7, v9
    s_mov_b32 exec_lo, s78
    s_mov_b32 exec_hi, 0
    buffer_load_dword v15, v9, s[28:31], s79 offen nt
    s_mov_b64 exec, -1
    v_mul_u32_u24 v9, 96, v0
    s_sub_u32 s78, s88, 32
    v_add_lshl_u32 v9, v9, s78, 10
    s_movk_i32 s79, 384
    s_mov_b64 exec, 0xffff
    buffer_load_dword v15, v9, s[32:35], s79 offen
    s_mov_b64 exec, -1
    s_mul_i32 s78, s60, 96
    s_add_u32 s78, s78, s88
    s_sub_u32 s78, s78, 32
    s_mul_i32 s79, s78, 16
    v_add_lshl_u32 v9, v0, s79, 7
    s_mov_b64 exec, 0xffff
    buffer_load_dword v15, v9, s[32:35], 0 offen
    s_mov_b64 exec, -1
    v_and_b32 v6, 31, v0
    s_lshl_b32 s72, s64, 3
    v_xor_b32 v6, s72, v6
    v_lshrrev_b32 v7, 5, v0
    v_lshlrev_b32 v7, 2, v7
    v_sub_u32 v6, v6, v7
    v_mov_b32 v7, 0x3f80
    v_mov_b32 v8, 0x3f800000
    v_cmp_eq_u32 vcc, 0, v6
    s_nop 1
    v_cndmask_b32 v240, 0, v7, vcc
    v_cmp_eq_u32 vcc, 1, v6
    s_nop 1
    v_cndmask_b32 v240, v240, v8, vcc
    v_cmp_eq_u32 vcc, 2, v6
    s_nop 1
    v_cndmask_b32 v241, 0, v7, vcc
    v_cmp_eq_u32 vcc, 3, v6
    s_nop 1
    v_cndmask_b32 v241, v241, v8, vcc
    v_cmp_eq_u32 vcc, 8, v6
    s_nop 1
    v_cndmask_b32 v242, 0, v7, vcc
    v_cmp_eq_u32 vcc, 9, v6
    s_nop 1
    v_cndmask_b32 v242, v242, v8, vcc
    v_cmp_eq_u32 vcc, 10, v6
    s_nop 1
    v_cndmask_b32 v243, 0, v7, vcc
    v_cmp_eq_u32 vcc, 11, v6
    s_nop 1
    v_cndmask_b32 v243, v243, v8, vcc
    v_cmp_eq_u32 vcc, 16, v6
    s_nop 1
    v_cndmask_b32 v244, 0, v7, vcc
    v_cmp_eq_u32 vcc, 17, v6
    s_nop 1
    v_cndmask_b32 v244, v244, v8, vcc
    v_cmp_eq_u32 vcc, 18, v6
    s_nop 1
    v_cndmask_b32 v245, 0, v7, vcc
    v_cmp_eq_u32 vcc, 19, v6
    s_nop 1
    v_cndmask_b32 v245, v245, v8, vcc
    v_cmp_eq_u32 vcc, 24, v6
    s_nop 1
    v_cndmask_b32 v246, 0, v7, vcc
    v_cmp_eq_u32 vcc, 25, v6
    s_nop 1
    v_cndmask_b32 v246, v246, v8, vcc
    v_cmp_eq_u32 vcc, 26, v6
    s_nop 1
    v_cndmask_b32 v247, 0, v7, vcc
    v_cmp_eq_u32 vcc, 27, v6
    s_nop 1
    v_cndmask_b32 v247, v247, v8, vcc
    s_waitcnt lgkmcnt(0)
    v_lshlrev_b32 v9, 7, v0
    s_mov_b32 s79, 0x1f000
    s_mov_b64 exec, 0xff
    buffer_load_dword v15, v9, s[56:59], s79 offen sc1
    s_mov_b64 exec, -1
    s_waitcnt vmcnt(4)
    s_waitcnt lgkmcnt(0)
    s_add_u32 s65, s65, 1
    s_cmp_lg_u32 s64, 1
    s_cbranch_scc1 nohello_2
    v_mov_b32 v6, s65
    v_mov_b32 v7, s83
    v_lshlrev_b32 v8, 3, v0
    s_lshl_b32 s72, s2, 7
    s_add_u32 s72, s72, 0x1000
    s_mov_b64 exec, 0xffff
    buffer_store_dwordx2 v[6:7], v8, s[52:55], s72 offen sc1
    s_mov_b64 exec, -1
nohello_2:
L_mrg:
    ds_read_b128 v[36:39], v45 offset:1024
    ds_read_b128 v[40:43], v45 offset:2048
    s_waitcnt lgkmcnt(0)
    v_lshlrev_b32 v64, 16, v36
    v_and_b32 v65, s71, v36
    v_lshlrev_b32 v66, 16, v37
    v_and_b32 v67, s71, v37
    v_lshlrev_b32 v68, 16, v38
    v_and_b32 v69, s71, v38
    v_lshlrev_b32 v70, 16, v39
    v_and_b32 v71, s71, v39
    v_lshlrev_b32 v72, 16, v40
    v_and_b32 v73, s71, v40
    v_lshlrev_b32 v74, 16, v41
    v_and_b32 v75, s71, v41
    v_lshlrev_b32 v76, 16, v42
    v_and_b32 v77, s71, v42
    v_lshlrev_b32 v78, 16, v43
    v_and_b32 v79, s71, v43
    v_pk_add_f32 v[80:81], v[64:65], v[66:67]
    v_pk_mul_f32 v[82:83], v[64:65], v[64:65]
    v_pk_fma_f32 v[82:83], v[66:67], v[66:67], v[82:83]
    v_pk_add_f32 v[80:81], v[80:81], v[68:69]
    v_pk_fma_f32 v[82:83], v[68:69], v[68:69], v[82:83]
    v_pk_add_f32 v[80:81], v[80:81], v[70:71]
    v_pk_fma_f32 v[82:83], v[70:71], v[70:71], v[82:83]
    v_pk_add_f32 v[80:81], v[80:81], v[72:73]
    v_pk_fma_f32 v[82:83], v[72:73], v[72:73], v[82:83]
    v_pk_add_f32 v[80:81], v[80:81], v[74:75]
    v_pk_fma_f32 v[82:83], v[74:75], v[74:75], v[82:83]
    v_pk_add_f32 v[80:81], v[80:81], v[76:77]
    v_pk_fma_f32 v[82:83], v[76:77], v[76:77], v[82:83]
    v_pk_add_f32 v[80:81], v[80:81], v[78:79]
    v_pk_fma_f32 v[82:83], v[78:79], v[78:79], v[82:83]
    v_add_f32 v80, v80, v81
    v_add_f32 v81, v82, v83
    s_nop 0
    v_add_f32_dpp v80, v80, v80 row_ror:8 row_mask:0xf bank_mask:0xf
    v_add_f32_dpp v81, v81, v81 row_ror:8 row_mask:0xf bank_mask:0xf
    v_mov_b32 v82, v80
    v_mov_b32 v83, v81
    s_nop 0
    v_permlane16_swap_b32 v80, v82
    v_permlane16_swap_b32 v81, v83
    v_pk_add_f32 v[80:81], v[80:81], v[82:83]
    v_mov_b32 v82, v80
    v_mov_b32 v83, v81
    s_nop 0
    v_permlane32_swap_b32 v80, v82
    v_permlane32_swap_b32 v81, v83
    v_pk_add_f32 v[80:81], v[80:81], v[82:83]
    v_and_b32 v6, 7, v0
    v_lshlrev_b32 v6, 3, v6
    v_add_u32 v7, s68, v6
    s_mov_b64 exec, 0xff
    ds_write_b64 v7, v[80:81] offset:15616
    s_mov_b64 exec, -1
    s_waitcnt lgkmcnt(0)
    s_barrier
    s_cmp_lt_u32 s61, 8
    s_cbranch_scc1 L_ml1
    s_mov_b32 s92, s8
    s_mov_b32 s93, s9
    s_mov_b32 s94, 0x4000
    s_mov_b32 s95, 0x00020000
    s_lshl_b32 s78, s63, 10
    s_add_u32 m0, s68, 0x3800
    s_add_u32 s79, s78, 0x0
    buffer_load_dwordx4 v1, s[92:95], s79 offen lds
    s_and_b32 s78, s62, 1
    s_lshl_b32 s78, s78, 1
    s_and_b32 s79, s63, 1
    s_or_b32 s78, s78, s79
    s_xor_b32 s79, s78, 0
    s_mul_i32 s79, s79, 98304
    s_add_u32 s92, s79, s91
    s_xor_b32 s79, s78, 1
    s_mul_i32 s79, s79, 98304
    s_add_u32 s93, s79, s91
    s_xor_b32 s79, s78, 2
    s_mul_i32 s79, s79, 98304
    s_add_u32 s94, s79, s91
    s_xor_b32 s79, s78, 3
    s_mul_i32 s79, s79, 98304
    s_add_u32 s95, s79, s91
    s_lshl_b32 s78, s78, 11
    s_add_u32 s97, s78, s96
    s_xor_b32 m0, s97, 0x10000
    s_add_u32 s79, s92, 0x400
    buffer_load_dwordx4 v239, s[32:35], s79 offen lds
    s_xor_b32 m0, s97, 0x18000
    s_add_u32 s79, s92, 0x800
    buffer_load_dwordx4 v239, s[32:35], s79 offen lds
    s_xor_b32 m0, s97, 0x10400
    s_add_u32 s79, s92, 0xc400
    buffer_load_dwordx4 v239, s[32:35], s79 offen lds
    s_xor_b32 m0, s97, 0x18400
    s_add_u32 s79, s92, 0xc800
    buffer_load_dwordx4 v239, s[32:35], s79 offen lds
    s_xor_b32 m0, s97, 0x10800
    s_add_u32 s79, s93, 0x400
    buffer_load_dwordx4 v239, s[32:35], s79 offen lds
    s_xor_b32 m0, s97, 0x18800
    s_add_u32 s79, s93, 0x800
    buffer_load_dwordx4 v239, s[32:35], s79 offen lds
    s_xor_b32 m0, s97, 0x10c00
    s_add_u32 s79, s93, 0xc400
    buffer_load_dwordx4 v239, s[32:35], s79 offen lds
    s_xor_b32 m0, s97, 0x18c00
    s_add_u32 s79, s93, 0xc800
    buffer_load_dwordx4 v239, s[32:35], s79 offen lds
    s_xor_b32 m0, s97, 0x11000
    s_add_u32 s79, s94, 0x400
    buffer_load_dwordx4 v239, s[32:35], s79 offen lds
    s_xor_b32 m0, s97, 0x19000
    s_add_u32 s79, s94, 0x800
    buffer_load_dwordx4 v239, s[32:35], s79 offen lds
    s_xor_b32 m0, s97, 0x11400
    s_add_u32 s79, s94, 0xc400
    buffer_load_dwordx4 v239, s[32:35], s79 offen lds
    s_xor_b32 m0, s97, 0x19400
    s_add_u32 s79, s94, 0xc800
    buffer_load_dwordx4 v239, s[32:35], s79 offen lds
    s_xor_b32 m0, s97, 0x11800
    s_add_u32 s79, s95, 0x400
    buffer_load_dwordx4 v239, s[32:35], s79 offen lds
    s_xor_b32 m0, s97, 0x19800
    s_add_u32 s79, s95, 0x800
    buffer_load_dwordx4 v239, s[32:35], s79 offen lds
    s_xor_b32 m0, s97, 0x11c00
    s_add_u32 s79, s95, 0xc400
    buffer_load_dwordx4 v239, s[32:35], s79 offen lds
    s_xor_b32 m0, s97, 0x19c00
    s_add_u32 s79, s95, 0xc800
    buffer_load_dwordx4 v239, s[32:35], s79 offen lds
L_ml1:
    v_add_u32 v6, 0x3d00, v6
    ds_read_b64 v[84:85], v6 offset:0
    ds_read_b64 v[86:87], v6 offset:16384
    ds_read_b64 v[88:89], v6 offset:32768
    ds_read_b64 v[90:91], v6 offset:49152
    s_waitcnt lgkmcnt(0)
    v_pk_add_f32 v[84:85], v[84:85], v[86:87]
    v_pk_add_f32 v[88:89], v[88:89], v[90:91]
    v_pk_add_f32 v[84:85], v[84:85], v[88:89]
    v_mul_f32 v84, 0x3b000000, v84
    v_mul_f32 v85, 0x3b000000, v85
    v_fma_f32 v85, -v84, v84, v85
    v_max_f32 v85, 0, v85
    v_add_f32 v85, 0x3727c5ac, v85
    v_rsq_f32 v86, v85
    s_nop 0
    v_mul_f32 v88, v84, v86
    v_pk_fma_f32 v[64:65], v[64:65], v[86:87], v[88:89] op_sel_hi:[1,0,0] neg_lo:[0,0,1] neg_hi:[0,0,1]
    v_pk_fma_f32 v[66:67], v[66:67], v[86:87], v[88:89] op_sel_hi:[1,0,0] neg_lo:[0,0,1] neg_hi:[0,0,1]
    v_pk_fma_f32 v[68:69], v[68:69], v[86:87], v[88:89] op_sel_hi:[1,0,0] neg_lo:[0,0,1] neg_hi:[0,0,1]
    v_pk_fma_f32 v[70:71], v[70:71], v[86:87], v[88:89] op_sel_hi:[1,0,0] neg_lo:[0,0,1] neg_hi:[0,0,1]
    v_pk_fma_f32 v[72:73], v[72:73], v[86:87], v[88:89] op_sel_hi:[1,0,0] neg_lo:[0,0,1] neg_hi:[0,0,1]
    v_pk_fma_f32 v[74:75], v[74:75], v[86:87], v[88:89] op_sel_hi:[1,0,0] neg_lo:[0,0,1] neg_hi:[0,0,1]
    v_pk_fma_f32 v[76:77], v[76:77], v[86:87], v[88:89] op_sel_hi:[1,0,0] neg_lo:[0,0,1] neg_hi:[0,0,1]
    v_pk_fma_f32 v[78:79], v[78:79], v[86:87], v[88:89] op_sel_hi:[1,0,0] neg_lo:[0,0,1] neg_hi:[0,0,1]
    v_and_b32 v6, 32, v0
    v_mul_u32_u24 v6, 0xf0, v6
    v_add_u32 v6, v6, v1
    s_lshl_b32 s72, s64, 9
    s_add_u32 s72, s72, 0x10000
    s_add_u32 s73, s72, 4096
    s_bfe_u32 s4, s65, 0x80000
    s_bfe_u32 s5, s65, 0x80008
    s_bfe_u32 s6, s65, 0x80010
    s_bfe_u32 s7, s65, 0x80018
    v_and_b32 v8, 15, v0
    v_lshlrev_b32 v8, 10, v8
    s_and_b32 s74, s2, 0x87
    s_lshl_b32 s74, s74, 7
    s_add_u32 s74, s74, 0x1000
    v_add_u32 v11, s68, v1
    v_cmp_lt_u32 vcc, 31, v0
    v_lshrrev_b32 v7, 3, v0
    s_nop 0
    v_cndmask_b32 v94, 0, 1.0, vcc
    v_lshlrev_b32 v12, 5, v7
    v_add_u32 v12, s68, v12
    v_lshlrev_b32 v13, 9, v7
    v_and_b32 v7, 7, v0
    v_lshl_add_u32 v13, v7, 4, v13
    s_lshr_b32 s75, s63, 2
    s_lshl_b32 s75, s75, 17
    s_lshl_b32 s76, s64, 13
    s_add_u32 s75, s75, s76
    s_and_b32 s76, s63, 3
    s_lshl_b32 s76, s76, 7
    s_add_u32 s75, s75, s76
    s_add_u32 s76, s75, 4096
    buffer_load_dwordx2 v[92:93], v8, s[52:55], s74 offen sc1
    buffer_load_dwordx4 v[128:131], v6, s[52:55], s72 offen offset:0 sc1
    buffer_load_dwordx4 v[132:135], v6, s[52:55], s72 offen offset:2048 sc1
    buffer_load_dwordx4 v[136:139], v6, s[52:55], s73 offen offset:0 sc1
    buffer_load_dwordx4 v[140:143], v6, s[52:55], s73 offen offset:2048 sc1
    s_branch chk_mod_5
poll_mod_3:
    s_nop 4
    buffer_load_dwordx2 v[92:93], v8, s[52:55], s74 offen sc1
    buffer_load_dwordx4 v[128:131], v6, s[52:55], s72 offen offset:0 sc1
    buffer_load_dwordx4 v[132:135], v6, s[52:55], s72 offen offset:2048 sc1
    buffer_load_dwordx4 v[136:139], v6, s[52:55], s73 offen offset:0 sc1
    buffer_load_dwordx4 v[140:143], v6, s[52:55], s73 offen offset:2048 sc1
    s_waitcnt vmcnt(0)
chk_mod_5:
    s_waitcnt vmcnt(3)
    v_cmp_ne_u32 vcc, s65, v92
    v_xor_b32 v128, s4, v128
    v_xor_b32 v129, s5, v129
    v_xor_b32 v130, s6, v130
    v_xor_b32 v131, s7, v131
    v_cndmask_b32 v92, 0, 1, vcc
    v_or3_b32 v92, v92, v128, v129
    v_or3_b32 v92, v92, v130, v131
    s_waitcnt vmcnt(2)
    v_xor_b32 v132, s4, v132
    v_xor_b32 v133, s5, v133
    v_xor_b32 v134, s6, v134
    v_xor_b32 v135, s7, v135
    v_or3_b32 v92, v92, v132, v133
    v_or3_b32 v92, v92, v134, v135
    v_pk_add_f32 v[128:129], v[128:129], v[132:133]
    v_pk_add_f32 v[130:131], v[130:131], v[134:135]
    s_waitcnt vmcnt(1)
    v_xor_b32 v136, s4, v136
    v_xor_b32 v137, s5, v137
    v_xor_b32 v138, s6, v138
    v_xor_b32 v139, s7, v139
    v_or3_b32 v92, v92, v136, v137
    v_or3_b32 v92, v92, v138, v139
    v_pk_add_f32 v[128:129], v[128:129], v[136:137]
    v_pk_add_f32 v[130:131], v[130:131], v[138:139]
    s_waitcnt vmcnt(0)
    v_xor_b32 v140, s4, v140
    v_xor_b32 v141, s5, v141
    v_xor_b32 v142, s6, v142
    v_xor_b32 v143, s7, v143
    v_or3_b32 v92, v92, v140, v141
    v_or3_b32 v92, v92, v142, v143
    v_pk_add_f32 v[128:129], v[128:129], v[140:141]
    v_pk_add_f32 v[130:131], v[130:131], v[142:143]
    v_and_b32 v92, 0xff, v92
    v_cmp_ne_u32 vcc, 0, v92
    s_cbranch_vccz done_mod_4
    s_sub_u32 s67, s67, 1
    s_cbranch_scc0 poll_mod_3
    s_endpgm
done_mod_4:
    v_cvt_pk_bf16_f32 v128, 0, v128
    v_cvt_pk_bf16_f32 v129, 0, v129
    v_cvt_pk_bf16_f32 v130, 0, v130
    v_cvt_pk_bf16_f32 v131, 0, v131
    v_add_f32 v128, v94, v128
    v_add_f32 v129, v94, v129
    v_add_f32 v130, v94, v130
    v_add_f32 v131, v94, v131
    v_cvt_pk_bf16_f32 v128, 0, v128
    v_cvt_pk_bf16_f32 v129, 0, v129
    v_cvt_pk_bf16_f32 v130, 0, v130
    v_cvt_pk_bf16_f32 v131, 0, v131
    ds_write_b128 v11, v[128:131]
    v_cmp_ne_u32 vcc, s83, v93
    ds_read_b128 v[112:115], v12 offset:512
    ds_read_b128 v[96:99], v12 offset:0
    ds_read_b128 v[116:119], v12 offset:528
    ds_read_b128 v[100:103], v12 offset:16
    ds_read_b128 v[120:123], v12 offset:768
    ds_read_b128 v[104:107], v12 offset:256
    ds_read_b128 v[124:127], v12 offset:784
    ds_read_b128 v[108:111], v12 offset:272
    s_cmp_eq_u64 vcc, 0
    s_cselect_b32 s66, 1, 0
    s_waitcnt lgkmcnt(4)
    v_pk_fma_f32 v[64:65], v[64:65], v[112:113], v[96:97]
    v_pk_fma_f32 v[66:67], v[66:67], v[114:115], v[98:99]
    v_pk_fma_f32 v[68:69], v[68:69], v[116:117], v[100:101]
    v_pk_fma_f32 v[70:71], v[70:71], v[118:119], v[102:103]
    v_cvt_pk_bf16_f32 v136, v64, v65
    v_cvt_pk_bf16_f32 v137, v66, v67
    v_cvt_pk_bf16_f32 v138, v68, v69
    v_cvt_pk_bf16_f32 v139, v70, v71
    s_waitcnt lgkmcnt(0)
    v_pk_fma_f32 v[72:73], v[72:73], v[120:121], v[104:105]
    v_pk_fma_f32 v[74:75], v[74:75], v[122:123], v[106:107]
    v_pk_fma_f32 v[76:77], v[76:77], v[124:125], v[108:109]
    v_pk_fma_f32 v[78:79], v[78:79], v[126:127], v[110:111]
    v_cvt_pk_bf16_f32 v140, v72, v73
    v_cvt_pk_bf16_f32 v141, v74, v75
    v_cvt_pk_bf16_f32 v142, v76, v77
    v_cvt_pk_bf16_f32 v143, v78, v79
    buffer_store_dwordx4 v[136:139], v13, s[56:59], s75 offen offset:0 sc1
    buffer_store_dwordx4 v[140:143], v13, s[56:59], s76 offen offset:0 sc1
    s_lshl_b32 s78, s63, 2
    s_add_u32 s78, s78, s64
    s_lshl_b32 s78, s78, 2
    s_add_u32 s78, s78, 0x1f000
    v_mov_b32 v9, s65
    s_mov_b64 exec, 1
    s_waitcnt vmcnt(0)
    s_cmp_eq_u32 s66, 0
    s_cbranch_scc1 imp_6
    buffer_store_dword v9, off, s[56:59], s78 offset:0
    s_branch join_7
imp_6:
    buffer_store_dword v9, off, s[56:59], s78 offset:0 sc1
join_7:
    s_mov_b64 exec, -1
    s_cmp_ge_u32 s61, 8
    s_cbranch_scc1 L_ml2
    s_mov_b32 s92, s8
    s_mov_b32 s93, s9
    s_mov_b32 s94, 0x4000
    s_mov_b32 s95, 0x00020000
    s_lshl_b32 s78, s63, 10
    s_add_u32 m0, s68, 0x3800
    s_add_u32 s79, s78, 0x0
    buffer_load_dwordx4 v1, s[92:95], s79 offen lds
    s_and_b32 s78, s62, 1
    s_lshl_b32 s78, s78, 1
    s_and_b32 s79, s63, 1
    s_or_b32 s78, s78, s79
    s_xor_b32 s79, s78, 0
    s_mul_i32 s79, s79, 98304
    s_add_u32 s92, s79, s91
    s_xor_b32 s79, s78, 1
    s_mul_i32 s79, s79, 98304
    s_add_u32 s93, s79, s91
    s_xor_b32 s79, s78, 2
    s_mul_i32 s79, s79, 98304
    s_add_u32 s94, s79, s91
    s_xor_b32 s79, s78, 3
    s_mul_i32 s79, s79, 98304
    s_add_u32 s95, s79, s91
    s_lshl_b32 s78, s78, 11
    s_add_u32 s97, s78, s96
    s_xor_b32 m0, s97, 0x10000
    s_add_u32 s79, s92, 0x400
    buffer_load_dwordx4 v239, s[32:35], s79 offen lds
    s_xor_b32 m0, s97, 0x18000
    s_add_u32 s79, s92, 0x800
    buffer_load_dwordx4 v239, s[32:35], s79 offen lds
    s_xor_b32 m0, s97, 0x10400
    s_add_u32 s79, s92, 0xc400
    buffer_load_dwordx4 v239, s[32:35], s79 offen lds
    s_xor_b32 m0, s97, 0x18400
    s_add_u32 s79, s92, 0xc800
    buffer_load_dwordx4 v239, s[32:35], s79 offen lds
    s_xor_b32 m0, s97, 0x10800
    s_add_u32 s79, s93, 0x400
    buffer_load_dwordx4 v239, s[32:35], s79 offen lds
    s_xor_b32 m0, s97, 0x18800
    s_add_u32 s79, s93, 0x800
    buffer_load_dwordx4 v239, s[32:35], s79 offen lds
    s_xor_b32 m0, s97, 0x10c00
    s_add_u32 s79, s93, 0xc400
    buffer_load_dwordx4 v239, s[32:35], s79 offen lds
    s_xor_b32 m0, s97, 0x18c00
    s_add_u32 s79, s93, 0xc800
    buffer_load_dwordx4 v239, s[32:35], s79 offen lds
    s_xor_b32 m0, s97, 0x11000
    s_add_u32 s79, s94, 0x400
    buffer_load_dwordx4 v239, s[32:35], s79 offen lds
    s_xor_b32 m0, s97, 0x19000
    s_add_u32 s79, s94, 0x800
    buffer_load_dwordx4 v239, s[32:35], s79 offen lds
    s_xor_b32 m0, s97, 0x11400
    s_add_u32 s79, s94, 0xc400
    buffer_load_dwordx4 v239, s[32:35], s79 offen lds
    s_xor_b32 m0, s97, 0x19400
    s_add_u32 s79, s94, 0xc800
    buffer_load_dwordx4 v239, s[32:35], s79 offen lds
    s_xor_b32 m0, s97, 0x11800
    s_add_u32 s79, s95, 0x400
    buffer_load_dwordx4 v239, s[32:35], s79 offen lds
    s_xor_b32 m0, s97, 0x19800
    s_add_u32 s79, s95, 0x800
    buffer_load_dwordx4 v239, s[32:35], s79 offen lds
    s_xor_b32 m0, s97, 0x11c00
    s_add_u32 s79, s95, 0xc400
    buffer_load_dwordx4 v239, s[32:35], s79 offen lds
    s_xor_b32 m0, s97, 0x19c00
    s_add_u32 s79, s95, 0xc800
    buffer_load_dwordx4 v239, s[32:35], s79 offen lds
L_ml2:
    v_lshrrev_b32 v6, 5, v0
    v_bfe_u32 v7, v0, 2, 2
    v_lshl_add_u32 v6, v6, 3, v7
    v_lshl_add_u32 v11, v6, 6, v10
    v_add_u32 v11, 0x10000, v11
    v_and_b32 v6, 15, v0
    s_lshl_b32 s72, s64, 4
    v_add_lshl_u32 v6, v6, s72, 2
    s_lshl_b32 s72, s64, 17
    s_bfe_u32 s73, s63, 0x20001
    s_lshl_b32 s73, s73, 13
    s_add_u32 s72, s72, s73
    s_mov_b32 s78, 0x1f000
    buffer_load_dword v200, v6, s[56:59], s78 offen sc1
    s_sleep 2
    buffer_load_dword v201, v6, s[56:59], s78 offen sc1
    s_sleep 2
    buffer_load_dword v202, v6, s[56:59], s78 offen sc1
poll_h_8:
    s_waitcnt vmcnt(2)
    v_cmp_ne_u32 vcc, s65, v200
    s_cbranch_vccz done_h_9
    buffer_load_dword v200, v6, s[56:59], s78 offen sc1
    s_waitcnt vmcnt(2)
    v_cmp_ne_u32 vcc, s65, v201
    s_cbranch_vccz done_h_9
    buffer_load_dword v201, v6, s[56:59], s78 offen sc1
    s_waitcnt vmcnt(2)
    v_cmp_ne_u32 vcc, s65, v202
    s_cbranch_vccz done_h_9
    buffer_load_dword v202, v6, s[56:59], s78 offen sc1
    s_sub_u32 s67, s67, 1
    s_cbranch_scc0 poll_h_8
    s_endpgm
done_h_9:
    s_xor_b32 s77, s72, 0x0
    buffer_load_dwordx4 v[16:19], v1, s[56:59], s77 offen offset:0 sc1
    buffer_load_dwordx4 v[20:23], v1, s[56:59], s77 offen offset:1024 sc1
    buffer_load_dwordx4 v[24:27], v1, s[56:59], s77 offen offset:2048 sc1
    buffer_load_dwordx4 v[28:31], v1, s[56:59], s77 offen offset:3072 sc1
    s_xor_b32 s77, s72, 0x1000
    buffer_load_dwordx4 v[32:35], v1, s[56:59], s77 offen offset:0 sc1
    buffer_load_dwordx4 v[36:39], v1, s[56:59], s77 offen offset:1024 sc1
    buffer_load_dwordx4 v[40:43], v1, s[56:59], s77 offen offset:2048 sc1
    buffer_load_dwordx4 v[44:47], v1, s[56:59], s77 offen offset:3072 sc1
    s_xor_b32 s77, s72, 0x2000
    buffer_load_dwordx4 v[48:51], v1, s[56:59], s77 offen offset:0 sc1
    buffer_load_dwordx4 v[52:55], v1, s[56:59], s77 offen offset:1024 sc1
    buffer_load_dwordx4 v[56:59], v1, s[56:59], s77 offen offset:2048 sc1
    buffer_load_dwordx4 v[60:63], v1, s[56:59], s77 offen offset:3072 sc1
    s_barrier
    ds_read_b64_tr_b16 v[176:177], v11 offset:0
    ds_read_b64_tr_b16 v[178:179], v11 offset:256
    ds_read_b64_tr_b16 v[180:181], v11 offset:32768
    ds_read_b64_tr_b16 v[182:183], v11 offset:33024
    ds_read_b64_tr_b16 v[184:185], v11 offset:1024
    ds_read_b64_tr_b16 v[186:187], v11 offset:1280
    ds_read_b64_tr_b16 v[188:189], v11 offset:33792
    ds_read_b64_tr_b16 v[190:191], v11 offset:34048
    s_waitcnt vmcnt(11)
    s_waitcnt lgkmcnt(6)
    v_mfma_f32_32x32x16_bf16 v[144:159], v[176:179], v[16:19], 0
    ds_read_b64_tr_b16 v[192:193], v11 offset:2048
    ds_read_b64_tr_b16 v[194:195], v11 offset:2304
    ds_read_b64_tr_b16 v[196:197], v11 offset:34816
    ds_read_b64_tr_b16 v[198:199], v11 offset:35072
    s_waitcnt lgkmcnt(8)
    v_mfma_f32_32x32x16_bf16 v[160:175], v[16:19], v[180:183], 0
    s_xor_b32 s77, s72, 0x3000
    buffer_load_dwordx4 v[64:67], v1, s[56:59], s77 offen offset:0 sc1
    buffer_load_dwordx4 v[68:71], v1, s[56:59], s77 offen offset:1024 sc1
    s_waitcnt vmcnt(12)
    s_waitcnt lgkmcnt(6)
    v_mfma_f32_32x32x16_bf16 v[144:159], v[184:187], v[20:23], v[144:159]
    ds_read_b64_tr_b16 v[176:177], v11 offset:3072
    ds_read_b64_tr_b16 v[178:179], v11 offset:3328
    ds_read_b64_tr_b16 v[180:181], v11 offset:35840
    ds_read_b64_tr_b16 v[182:183], v11 offset:36096
    s_waitcnt lgkmcnt(8)
    v_mfma_f32_32x32x16_bf16 v[160:175], v[20:23], v[188:191], v[160:175]
    buffer_load_dwordx4 v[72:75], v1, s[56:59], s77 offen offset:2048 sc1
    buffer_load_dwordx4 v[76:79], v1, s[56:59], s77 offen offset:3072 sc1
    s_waitcnt vmcnt(13)
    s_waitcnt lgkmcnt(6)
    v_mfma_f32_32x32x16_bf16 v[144:159], v[192:195], v[24:27], v[144:159]
    ds_read_b64_tr_b16 v[184:185], v11 offset:4096
    ds_read_b64_tr_b16 v[186:187], v11 offset:4352
    ds_read_b64_tr_b16 v[188:189], v11 offset:36864
    ds_read_b64_tr_b16 v[190:191], v11 offset:37120
    s_waitcnt lgkmcnt(8)
    v_mfma_f32_32x32x16_bf16 v[160:175], v[24:27], v[196:199], v[160:175]
    s_xor_b32 s77, s72, 0x4000
    buffer_load_dwordx4 v[80:83], v1, s[56:59], s77 offen offset:0 sc1
    buffer_load_dwordx4 v[84:87], v1, s[56:59], s77 offen offset:1024 sc1
    s_waitcnt vmcnt(14)
    s_waitcnt lgkmcnt(6)
    v_mfma_f32_32x32x16_bf16 v[144:159], v[176:179], v[28:31], v[144:159]
    ds_read_b64_tr_b16 v[192:193], v11 offset:5120
    ds_read_b64_tr_b16 v[194:195], v11 offset:5376
    ds_read_b64_tr_b16 v[196:197], v11 offset:37888
    ds_read_b64_tr_b16 v[198:199], v11 offset:38144
    s_waitcnt lgkmcnt(8)
    v_mfma_f32_32x32x16_bf16 v[160:175], v[28:31], v[180:183], v[160:175]
    buffer_load_dwordx4 v[88:91], v1, s[56:59], s77 offen offset:2048 sc1
    buffer_load_dwordx4 v[92:95], v1, s[56:59], s77 offen offset:3072 sc1
    s_waitcnt vmcnt(15)
    s_waitcnt lgkmcnt(6)
    v_mfma_f32_32x32x16_bf16 v[144:159], v[184:187], v[32:35], v[144:159]
    ds_read_b64_tr_b16 v[176:177], v11 offset:6144
    ds_read_b64_tr_b16 v[178:179], v11 offset:6400
    ds_read_b64_tr_b16 v[180:181], v11 offset:38912
    ds_read_b64_tr_b16 v[182:183], v11 offset:39168
    s_waitcnt lgkmcnt(8)
    v_mfma_f32_32x32x16_bf16 v[160:175], v[32:35], v[188:191], v[160:175]
    s_xor_b32 s77, s72, 0x5000
    buffer_load_dwordx4 v[96:99], v1, s[56:59], s77 offen offset:0 sc1
    buffer_load_dwordx4 v[100:103], v1, s[56:59], s77 offen offset:1024 sc1
    s_waitcnt vmcnt(16)
    s_waitcnt lgkmcnt(6)
    v_mfma_f32_32x32x16_bf16 v[144:159], v[192:195], v[36:39], v[144:159]
    ds_read_b64_tr_b16 v[184:185], v11 offset:7168
    ds_read_b64_tr_b16 v[186:187], v11 offset:7424
    ds_read_b64_tr_b16 v[188:189], v11 offset:39936
    ds_read_b64_tr_b16 v[190:191], v11 offset:40192
    s_waitcnt lgkmcnt(8)
    v_mfma_f32_32x32x16_bf16 v[160:175], v[36:39], v[196:199], v[160:175]
    buffer_load_dwordx4 v[104:107], v1, s[56:59], s77 offen offset:2048 sc1
    buffer_load_dwordx4 v[108:111], v1, s[56:59], s77 offen offset:3072 sc1
    s_waitcnt vmcnt(17)
    s_waitcnt lgkmcnt(6)
    v_mfma_f32_32x32x16_bf16 v[144:159], v[176:179], v[40:43], v[144:159]
    ds_read_b64_tr_b16 v[192:193], v11 offset:8192
    ds_read_b64_tr_b16 v[194:195], v11 offset:8448
    ds_read_b64_tr_b16 v[196:197], v11 offset:40960
    ds_read_b64_tr_b16 v[198:199], v11 offset:41216
    s_waitcnt lgkmcnt(8)
    v_mfma_f32_32x32x16_bf16 v[160:175], v[40:43], v[180:183], v[160:175]
    s_xor_b32 s77, s72, 0x6000
    buffer_load_dwordx4 v[112:115], v1, s[56:59], s77 offen offset:0 sc1
    buffer_load_dwordx4 v[116:119], v1, s[56:59], s77 offen offset:1024 sc1
    s_waitcnt vmcnt(18)
    s_waitcnt lgkmcnt(6)
    v_mfma_f32_32x32x16_bf16 v[144:159], v[184:187], v[44:47], v[144:159]
    ds_read_b64_tr_b16 v[176:177], v11 offset:9216
    ds_read_b64_tr_b16 v[178:179], v11 offset:9472
    ds_read_b64_tr_b16 v[180:181], v11 offset:41984
    ds_read_b64_tr_b16 v[182:183], v11 offset:42240
    s_waitcnt lgkmcnt(8)
    v_mfma_f32_32x32x16_bf16 v[160:175], v[44:47], v[188:191], v[160:175]
    buffer_load_dwordx4 v[120:123], v1, s[56:59], s77 offen offset:2048 sc1
    buffer_load_dwordx4 v[124:127], v1, s[56:59], s77 offen offset:3072 sc1
    s_waitcnt vmcnt(19)
    s_waitcnt lgkmcnt(6)
    v_mfma_f32_32x32x16_bf16 v[144:159], v[192:195], v[48:51], v[144:159]
    ds_read_b64_tr_b16 v[184:185], v11 offset:10240
    ds_read_b64_tr_b16 v[186:187], v11 offset:10496
    ds_read_b64_tr_b16 v[188:189], v11 offset:43008
    ds_read_b64_tr_b16 v[190:191], v11 offset:43264
    s_waitcnt lgkmcnt(8)
    v_mfma_f32_32x32x16_bf16 v[160:175], v[48:51], v[196:199], v[160:175]
    s_xor_b32 s77, s72, 0x7000
    buffer_load_dwordx4 v[128:131], v1, s[56:59], s77 offen offset:0 sc1
    buffer_load_dwordx4 v[132:135], v1, s[56:59], s77 offen offset:1024 sc1
    v_bfe_u32 v6, v0, 4, 1
    v_cmp_eq_u32 vcc, 0, v6
    v_lshlrev_b32 v6, 9, v6
    v_and_b32 v7, 15, v0
    v_lshl_add_u32 v6, v7, 3, v6
    v_and_b32 v7, 32, v0
    v_lshlrev_b32 v7, 2, v7
    v_add3_u32 v6, v6, v7, s68
    ds_read_b64_tr_b16 v[248:249], v6 offset:14336
    ds_read_b64_tr_b16 v[250:251], v6 offset:14592
    s_waitcnt vmcnt(20)
    s_waitcnt lgkmcnt(8)
    v_mfma_f32_32x32x16_bf16 v[144:159], v[176:179], v[52:55], v[144:159]
    ds_read_b64_tr_b16 v[192:193], v11 offset:11264
    ds_read_b64_tr_b16 v[194:195], v11 offset:11520
    ds_read_b64_tr_b16 v[196:197], v11 offset:44032
    ds_read_b64_tr_b16 v[198:199], v11 offset:44288
    s_waitcnt lgkmcnt(10)
    v_mfma_f32_32x32x16_bf16 v[160:175], v[52:55], v[180:183], v[160:175]
    buffer_load_dwordx4 v[136:139], v1, s[56:59], s77 offen offset:2048 sc1
    buffer_load_dwordx4 v[140:143], v1, s[56:59], s77 offen offset:3072 sc1
    s_waitcnt vmcnt(21)
    s_waitcnt lgkmcnt(8)
    v_mfma_f32_32x32x16_bf16 v[144:159], v[184:187], v[56:59], v[144:159]
    ds_read_b64_tr_b16 v[176:177], v11 offset:12288
    ds_read_b64_tr_b16 v[178:179], v11 offset:12544
    ds_read_b64_tr_b16 v[180:181], v11 offset:45056
    ds_read_b64_tr_b16 v[182:183], v11 offset:45312
    s_waitcnt lgkmcnt(10)
    v_mfma_f32_32x32x16_bf16 v[160:175], v[56:59], v[188:191], v[160:175]
    s_add_u32 m0, s96, 0x20000
    s_add_u32 s79, s91, 0x0
    buffer_load_dwordx4 v239, s[32:35], s79 offen lds
    s_waitcnt vmcnt(21)
    s_waitcnt lgkmcnt(6)
    v_mfma_f32_32x32x16_bf16 v[144:159], v[192:195], v[60:63], v[144:159]
    ds_read_b64_tr_b16 v[184:185], v11 offset:13312
    ds_read_b64_tr_b16 v[186:187], v11 offset:13568
    ds_read_b64_tr_b16 v[188:189], v11 offset:46080
    ds_read_b64_tr_b16 v[190:191], v11 offset:46336
    s_waitcnt lgkmcnt(8)
    v_mfma_f32_32x32x16_bf16 v[160:175], v[60:63], v[196:199], v[160:175]
    s_add_u32 m0, s96, 0x20400
    s_add_u32 s79, s91, 0xc000
    buffer_load_dwordx4 v239, s[32:35], s79 offen lds
    v_cndmask_b32 v252, v248, 0, vcc
    v_cndmask_b32 v253, v249, 0, vcc
    v_cndmask_b32 v254, v250, 0, vcc
    v_cndmask_b32 v255, v251, 0, vcc
    v_cndmask_b32 v248, 0, v248, vcc
    v_cndmask_b32 v249, 0, v249, vcc
    v_cndmask_b32 v250, 0, v250, vcc
    v_cndmask_b32 v251, 0, v251, vcc
    s_waitcnt vmcnt(21)
    s_waitcnt lgkmcnt(6)
    v_mfma_f32_32x32x16_bf16 v[144:159], v[176:179], v[64:67], v[144:159]
    ds_read_b64_tr_b16 v[192:193], v11 offset:14336
    ds_read_b64_tr_b16 v[194:195], v11 offset:14592
    ds_read_b64_tr_b16 v[196:197], v11 offset:47104
    ds_read_b64_tr_b16 v[198:199], v11 offset:47360
    s_waitcnt lgkmcnt(8)
    v_mfma_f32_32x32x16_bf16 v[160:175], v[64:67], v[180:183], v[160:175]
    s_add_u32 m0, s96, 0x20800
    s_add_u32 s79, s91, 0x18000
    buffer_load_dwordx4 v239, s[32:35], s79 offen lds
    s_waitcnt vmcnt(21)
    s_waitcnt lgkmcnt(6)
    v_mfma_f32_32x32x16_bf16 v[144:159], v[184:187], v[68:71], v[144:159]
    ds_read_b64_tr_b16 v[176:177], v11 offset:15360
    ds_read_b64_tr_b16 v[178:179], v11 offset:15616
    ds_read_b64_tr_b16 v[180:181], v11 offset:48128
    ds_read_b64_tr_b16 v[182:183], v11 offset:48384
    s_waitcnt lgkmcnt(8)
    v_mfma_f32_32x32x16_bf16 v[160:175], v[68:71], v[188:191], v[160:175]
    s_add_u32 m0, s96, 0x20c00
    s_add_u32 s79, s91, 0x24000
    buffer_load_dwordx4 v239, s[32:35], s79 offen lds
    s_waitcnt vmcnt(21)
    s_waitcnt lgkmcnt(6)
    v_mfma_f32_32x32x16_bf16 v[144:159], v[192:195], v[72:75], v[144:159]
    ds_read_b64_tr_b16 v[184:185], v11 offset:16384
    ds_read_b64_tr_b16 v[186:187], v11 offset:16640
    ds_read_b64_tr_b16 v[188:189], v11 offset:49152
    ds_read_b64_tr_b16 v[190:191], v11 offset:49408
    s_waitcnt lgkmcnt(8)
    v_mfma_f32_32x32x16_bf16 v[160:175], v[72:75], v[196:199], v[160:175]
    s_add_u32 m0, s96, 0x21000
    s_add_u32 s79, s91, 0x30000
    buffer_load_dwordx4 v239, s[32:35], s79 offen lds
    s_waitcnt vmcnt(21)
    s_waitcnt lgkmcnt(6)
    v_mfma_f32_32x32x16_bf16 v[144:159], v[176:179], v[76:79], v[144:159]
    ds_read_b64_tr_b16 v[192:193], v11 offset:17408
    ds_read_b64_tr_b16 v[194:195], v11 offset:17664
    ds_read_b64_tr_b16 v[196:197], v11 offset:50176
    ds_read_b64_tr_b16 v[198:199], v11 offset:50432
    s_waitcnt lgkmcnt(8)
    v_mfma_f32_32x32x16_bf16 v[160:175], v[76:79], v[180:183], v[160:175]
    s_add_u32 m0, s96, 0x21400
    s_add_u32 s79, s91, 0x3c000
    buffer_load_dwordx4 v239, s[32:35], s79 offen lds
    s_waitcnt vmcnt(21)
    s_waitcnt lgkmcnt(6)
    v_mfma_f32_32x32x16_bf16 v[144:159], v[184:187], v[80:83], v[144:159]
    ds_read_b64_tr_b16 v[176:177], v11 offset:18432
    ds_read_b64_tr_b16 v[178:179], v11 offset:18688
    ds_read_b64_tr_b16 v[180:181], v11 offset:51200
    ds_read_b64_tr_b16 v[182:183], v11 offset:51456
    s_waitcnt lgkmcnt(8)
    v_mfma_f32_32x32x16_bf16 v[160:175], v[80:83], v[188:191], v[160:175]
    s_add_u32 m0, s96, 0x21800
    s_add_u32 s79, s91, 0x48000
    buffer_load_dwordx4 v239, s[32:35], s79 offen lds
    s_waitcnt vmcnt(21)
    s_waitcnt lgkmcnt(6)
    v_mfma_f32_32x32x16_bf16 v[144:159], v[192:195], v[84:87], v[144:159]
    ds_read_b64_tr_b16 v[184:185], v11 offset:19456
    ds_read_b64_tr_b16 v[186:187], v11 offset:19712
    ds_read_b64_tr_b16 v[188:189], v11 offset:52224
    ds_read_b64_tr_b16 v[190:191], v11 offset:52480
    s_waitcnt lgkmcnt(8)
    v_mfma_f32_32x32x16_bf16 v[160:175], v[84:87], v[196:199], v[160:175]
    s_add_u32 m0, s96, 0x21c00
    s_add_u32 s79, s91, 0x54000
    buffer_load_dwordx4 v239, s[32:35], s79 offen lds
    s_waitcnt vmcnt(21)
    s_waitcnt lgkmcnt(6)
    v_mfma_f32_32x32x16_bf16 v[144:159], v[176:179], v[88:91], v[144:159]
    ds_read_b64_tr_b16 v[192:193], v11 offset:20480
    ds_read_b64_tr_b16 v[194:195], v11 offset:20736
    ds_read_b64_tr_b16 v[196:197], v11 offset:53248
    ds_read_b64_tr_b16 v[198:199], v11 offset:53504
    s_waitcnt lgkmcnt(8)
    v_mfma_f32_32x32x16_bf16 v[160:175], v[88:91], v[180:183], v[160:175]
    v_mul_u32_u24 v9, 128, v0
    s_sub_u32 s78, s88, 0
    v_add_lshl_u32 v9, v9, s78, 10
    s_movk_i32 s79, 384
    s_mov_b64 exec, 0xf
    buffer_load_dword v15, v9, s[36:39], s79 offen
    s_mov_b64 exec, -1
    s_waitcnt vmcnt(21)
    s_waitcnt lgkmcnt(6)
    v_mfma_f32_32x32x16_bf16 v[144:159], v[184:187], v[92:95], v[144:159]
    ds_read_b64_tr_b16 v[176:177], v11 offset:21504
    ds_read_b64_tr_b16 v[178:179], v11 offset:21760
    ds_read_b64_tr_b16 v[180:181], v11 offset:54272
    ds_read_b64_tr_b16 v[182:183], v11 offset:54528
    s_waitcnt lgkmcnt(8)
    v_mfma_f32_32x32x16_bf16 v[160:175], v[92:95], v[188:191], v[160:175]
    s_mul_i32 s78, s60, 128
    s_add_u32 s78, s78, s88
    s_mul_i32 s79, s78, 11
    v_add_lshl_u32 v9, v0, s79, 7
    s_mov_b64 exec, 0x7ff
    buffer_load_dword v15, v9, s[40:43], 0 offen
    s_mov_b64 exec, -1
    s_waitcnt vmcnt(21)
    s_waitcnt lgkmcnt(6)
    v_mfma_f32_32x32x16_bf16 v[144:159], v[192:195], v[96:99], v[144:159]
    ds_read_b64_tr_b16 v[184:185], v11 offset:22528
    ds_read_b64_tr_b16 v[186:187], v11 offset:22784
    ds_read_b64_tr_b16 v[188:189], v11 offset:55296
    ds_read_b64_tr_b16 v[190:191], v11 offset:55552
    s_waitcnt lgkmcnt(8)
    v_mfma_f32_32x32x16_bf16 v[160:175], v[96:99], v[196:199], v[160:175]
    s_waitcnt vmcnt(20)
    s_waitcnt lgkmcnt(6)
    v_mfma_f32_32x32x16_bf16 v[144:159], v[176:179], v[100:103], v[144:159]
    ds_read_b64_tr_b16 v[192:193], v11 offset:23552
    ds_read_b64_tr_b16 v[194:195], v11 offset:23808
    ds_read_b64_tr_b16 v[196:197], v11 offset:56320
    ds_read_b64_tr_b16 v[198:199], v11 offset:56576
    s_waitcnt lgkmcnt(8)
    v_mfma_f32_32x32x16_bf16 v[160:175], v[100:103], v[180:183], v[160:175]
    s_waitcnt vmcnt(19)
    s_waitcnt lgkmcnt(6)
    v_mfma_f32_32x32x16_bf16 v[144:159], v[184:187], v[104:107], v[144:159]
    ds_read_b64_tr_b16 v[176:177], v11 offset:24576
    ds_read_b64_tr_b16 v[178:179], v11 offset:24832
    ds_read_b64_tr_b16 v[180:181], v11 offset:57344
    ds_read_b64_tr_b16 v[182:183], v11 offset:57600
    s_waitcnt lgkmcnt(8)
    v_mfma_f32_32x32x16_bf16 v[160:175], v[104:107], v[188:191], v[160:175]
    s_waitcnt vmcnt(18)
    s_waitcnt lgkmcnt(6)
    v_mfma_f32_32x32x16_bf16 v[144:159], v[192:195], v[108:111], v[144:159]
    ds_read_b64_tr_b16 v[184:185], v11 offset:25600
    ds_read_b64_tr_b16 v[186:187], v11 offset:25856
    ds_read_b64_tr_b16 v[188:189], v11 offset:58368
    ds_read_b64_tr_b16 v[190:191], v11 offset:58624
    s_waitcnt lgkmcnt(8)
    v_mfma_f32_32x32x16_bf16 v[160:175], v[108:111], v[196:199], v[160:175]
    s_waitcnt vmcnt(17)
    s_waitcnt lgkmcnt(6)
    v_mfma_f32_32x32x16_bf16 v[144:159], v[176:179], v[112:115], v[144:159]
    ds_read_b64_tr_b16 v[192:193], v11 offset:26624
    ds_read_b64_tr_b16 v[194:195], v11 offset:26880
    ds_read_b64_tr_b16 v[196:197], v11 offset:59392
    ds_read_b64_tr_b16 v[198:199], v11 offset:59648
    s_waitcnt lgkmcnt(8)
    v_mfma_f32_32x32x16_bf16 v[160:175], v[112:115], v[180:183], v[160:175]
    s_waitcnt vmcnt(16)
    s_waitcnt lgkmcnt(6)
    v_mfma_f32_32x32x16_bf16 v[144:159], v[184:187], v[116:119], v[144:159]
    ds_read_b64_tr_b16 v[176:177], v11 offset:27648
    ds_read_b64_tr_b16 v[178:179], v11 offset:27904
    ds_read_b64_tr_b16 v[180:181], v11 offset:60416
    ds_read_b64_tr_b16 v[182:183], v11 offset:60672
    s_waitcnt lgkmcnt(8)
    v_mfma_f32_32x32x16_bf16 v[160:175], v[116:119], v[188:191], v[160:175]
    s_waitcnt vmcnt(15)
    s_waitcnt lgkmcnt(6)
    v_mfma_f32_32x32x16_bf16 v[144:159], v[192:195], v[120:123], v[144:159]
    ds_read_b64_tr_b16 v[184:185], v11 offset:28672
    ds_read_b64_tr_b16 v[186:187], v11 offset:28928
    ds_read_b64_tr_b16 v[188:189], v11 offset:61440
    ds_read_b64_tr_b16 v[190:191], v11 offset:61696
    s_waitcnt lgkmcnt(8)
    v_mfma_f32_32x32x16_bf16 v[160:175], v[120:123], v[196:199], v[160:175]
    s_waitcnt vmcnt(14)
    s_waitcnt lgkmcnt(6)
    v_mfma_f32_32x32x16_bf16 v[144:159], v[176:179], v[124:127], v[144:159]
    ds_read_b64_tr_b16 v[192:193], v11 offset:29696
    ds_read_b64_tr_b16 v[194:195], v11 offset:29952
    ds_read_b64_tr_b16 v[196:197], v11 offset:62464
    ds_read_b64_tr_b16 v[198:199], v11 offset:62720
    s_waitcnt lgkmcnt(8)
    v_mfma_f32_32x32x16_bf16 v[160:175], v[124:127], v[180:183], v[160:175]
    s_waitcnt vmcnt(13)
    s_waitcnt lgkmcnt(6)
    v_mfma_f32_32x32x16_bf16 v[144:159], v[184:187], v[128:131], v[144:159]
    ds_read_b64_tr_b16 v[176:177], v11 offset:30720
    ds_read_b64_tr_b16 v[178:179], v11 offset:30976
    ds_read_b64_tr_b16 v[180:181], v11 offset:63488
    ds_read_b64_tr_b16 v[182:183], v11 offset:63744
    s_waitcnt lgkmcnt(8)
    v_mfma_f32_32x32x16_bf16 v[160:175], v[128:131], v[188:191], v[160:175]
    s_waitcnt vmcnt(12)
    s_waitcnt lgkmcnt(6)
    v_mfma_f32_32x32x16_bf16 v[144:159], v[192:195], v[132:135], v[144:159]
    ds_read_b64_tr_b16 v[184:185], v11 offset:31744
    ds_read_b64_tr_b16 v[186:187], v11 offset:32000
    ds_read_b64_tr_b16 v[188:189], v11 offset:64512
    ds_read_b64_tr_b16 v[190:191], v11 offset:64768
    s_waitcnt lgkmcnt(8)
    v_mfma_f32_32x32x16_bf16 v[160:175], v[132:135], v[196:199], v[160:175]
    s_waitcnt vmcnt(11)
    s_waitcnt lgkmcnt(6)
    v_mfma_f32_32x32x16_bf16 v[144:159], v[176:179], v[136:139], v[144:159]
    s_waitcnt lgkmcnt(4)
    v_mfma_f32_32x32x16_bf16 v[160:175], v[136:139], v[180:183], v[160:175]
    s_waitcnt vmcnt(10)
    s_waitcnt lgkmcnt(2)
    v_mfma_f32_32x32x16_bf16 v[144:159], v[184:187], v[140:143], v[144:159]
    s_waitcnt lgkmcnt(0)
    v_mfma_f32_32x32x16_bf16 v[160:175], v[140:143], v[188:191], v[160:175]
    s_nop 9
    v_cvt_pk_bf16_f32 v176, v144, v145
    v_cvt_pk_bf16_f32 v177, v146, v147
    v_cvt_pk_bf16_f32 v178, v148, v149
    v_cvt_pk_bf16_f32 v179, v150, v151
    v_cvt_pk_bf16_f32 v180, v152, v153
    v_cvt_pk_bf16_f32 v181, v154, v155
    v_cvt_pk_bf16_f32 v182, v156, v157
    v_cvt_pk_bf16_f32 v183, v158, v159
    v_mfma_f32_32x32x16_bf16 v[184:199], v[248:251], v[176:179], 0
    s_nop 0
    v_mfma_f32_32x32x16_bf16 v[184:199], v[252:255], v[180:183], v[184:199]
    v_cvt_pk_bf16_f32 v160, v160, v161
    v_cvt_pk_bf16_f32 v161, v162, v163
    v_cvt_pk_bf16_f32 v162, v164, v165
    s_add_u32 m0, s68, 0x0
    s_add_u32 s79, s12, 0x0
    buffer_load_dwordx4 v4, s[36:39], s79 offen lds
    v_cvt_pk_bf16_f32 v163, v166, v167
    v_cvt_pk_bf16_f32 v164, v168, v169
    v_cvt_pk_bf16_f32 v165, v170, v171
    v_cvt_pk_bf16_f32 v166, v172, v173
    v_cvt_pk_bf16_f32 v167, v174, v175
    v_bfe_u32 v6, v0, 4, 1
    v_cmp_eq_u32 vcc, 0, v6
    s_nop 1
    v_cndmask_b32 v168, v160, 0, vcc
    v_cndmask_b32 v169, v161, 0, vcc
    v_cndmask_b32 v170, v162, 0, vcc
    v_cndmask_b32 v171, v163, 0, vcc
    v_cndmask_b32 v172, v164, 0, vcc
    v_cndmask_b32 v173, v165, 0, vcc
    v_cndmask_b32 v174, v166, 0, vcc
    v_cndmask_b32 v175, v167, 0, vcc
    v_cndmask_b32 v160, 0, v160, vcc
    v_cndmask_b32 v161, 0, v161, vcc
    v_cndmask_b32 v162, 0, v162, vcc
    v_cndmask_b32 v163, 0, v163, vcc
    v_cndmask_b32 v164, 0, v164, vcc
    v_cndmask_b32 v165, 0, v165, vcc
    v_cndmask_b32 v166, 0, v166, vcc
    v_cndmask_b32 v167, 0, v167, vcc
    s_add_u32 m0, s68, 0x400
    s_add_u32 s79, s12, 0x2000
    buffer_load_dwordx4 v4, s[36:39], s79 offen lds
    v_max3_f32 v232, v184, v185, v186
    v_max3_f32 v232, v232, v187, v188
    v_max3_f32 v232, v232, v189, v190
    v_max_f32 v232, v232, v191
    v_min3_f32 v234, v184, v185, v186
    v_min3_f32 v234, v234, v187, v188
    v_min3_f32 v234, v234, v189, v190
    v_min_f32 v234, v234, v191
    v_max3_f32 v233, v192, v193, v194
    v_max3_f32 v233, v233, v195, v196
    v_max3_f32 v233, v233, v197, v198
    v_max_f32 v233, v233, v199
    v_min3_f32 v235, v192, v193, v194
    v_min3_f32 v235, v235, v195, v196
    v_min3_f32 v235, v235, v197, v198
    v_min_f32 v235, v235, v199
    v_permlane32_swap_b32 v232, v233
    v_max_f32 v232, v232, v233
    v_mul_f32 v232, s69, v232
    v_mov_b32 v233, v232
    s_nop 1
    v_permlane32_swap_b32 v232, v233
    v_permlane32_swap_b32 v234, v235
    v_min_f32 v234, v234, v235
    s_add_u32 m0, s68, 0x800
    s_add_u32 s79, s12, 0x4000
    buffer_load_dwordx4 v4, s[36:39], s79 offen lds
    v_mul_f32 v234, s69, v234
    v_mov_b32 v235, v234
    s_nop 1
    v_permlane32_swap_b32 v234, v235
    v_fma_f32 v200, v184, s69, -v232
    v_fma_f32 v208, -v184, s69, v234
    v_fma_f32 v201, v185, s69, -v232
    v_fma_f32 v209, -v185, s69, v234
    v_fma_f32 v202, v186, s69, -v232
    v_fma_f32 v210, -v186, s69, v234
    v_fma_f32 v203, v187, s69, -v232
    v_fma_f32 v211, -v187, s69, v234
    v_fma_f32 v204, v188, s69, -v232
    v_fma_f32 v212, -v188, s69, v234
    v_fma_f32 v205, v189, s69, -v232
    v_fma_f32 v213, -v189, s69, v234
    v_fma_f32 v206, v190, s69, -v232
    v_fma_f32 v214, -v190, s69, v234
    v_fma_f32 v207, v191, s69, -v232
    v_fma_f32 v215, -v191, s69, v234
    v_fma_f32 v216, v192, s69, -v233
    v_fma_f32 v224, -v192, s69, v235
    v_fma_f32 v217, v193, s69, -v233
    v_fma_f32 v225, -v193, s69, v235
    s_add_u32 m0, s68, 0xc00
    s_add_u32 s79, s12, 0x6000
    buffer_load_dwordx4 v4, s[36:39], s79 offen lds
    v_fma_f32 v218, v194, s69, -v233
    v_fma_f32 v226, -v194, s69, v235
    v_fma_f32 v219, v195, s69, -v233
    v_fma_f32 v227, -v195, s69, v235
    v_fma_f32 v220, v196, s69, -v233
    v_fma_f32 v228, -v196, s69, v235
    v_fma_f32 v221, v197, s69, -v233
    v_fma_f32 v229, -v197, s69, v235
    v_fma_f32 v222, v198, s69, -v233
    v_fma_f32 v230, -v198, s69, v235
    v_fma_f32 v223, v199, s69, -v233
    v_fma_f32 v231, -v199, s69, v235
    v_exp_f32 v200, v200
    v_exp_f32 v201, v201
    v_exp_f32 v202, v202
    s_add_u32 m0, s68, 0x1000
    s_add_u32 s79, s12, 0x8000
    buffer_load_dwordx4 v4, s[36:39], s79 offen lds
    v_exp_f32 v203, v203
    v_exp_f32 v204, v204
    v_exp_f32 v205, v205
    v_exp_f32 v206, v206
    v_exp_f32 v207, v207
    v_exp_f32 v208, v208
    s_add_u32 m0, s68, 0x1400
    s_add_u32 s79, s12, 0xa000
    buffer_load_dwordx4 v4, s[36:39], s79 offen lds
    v_exp_f32 v209, v209
    v_exp_f32 v210, v210
    v_exp_f32 v211, v211
    v_exp_f32 v212, v212
    v_exp_f32 v213, v213
    v_exp_f32 v214, v214
    s_add_u32 m0, s68, 0x1800
    s_add_u32 s79, s12, 0xc000
    buffer_load_dwordx4 v4, s[36:39], s79 offen lds
    v_exp_f32 v215, v215
    v_exp_f32 v216, v216
    v_exp_f32 v217, v217
    v_exp_f32 v218, v218
    v_exp_f32 v219, v219
    v_exp_f32 v220, v220
    s_add_u32 m0, s68, 0x1c00
    s_add_u32 s79, s12, 0xe000
    buffer_load_dwordx4 v4, s[36:39], s79 offen lds
    v_exp_f32 v221, v221
    v_exp_f32 v222, v222
    v_exp_f32 v223, v223
    v_exp_f32 v224, v224
    v_exp_f32 v225, v225
    v_exp_f32 v226, v226
    s_add_u32 m0, s68, 0x2000
    s_add_u32 s79, s12, 0x10000
    buffer_load_dwordx4 v4, s[36:39], s79 offen lds
    v_exp_f32 v227, v227
    v_exp_f32 v228, v228
    v_exp_f32 v229, v229
    v_exp_f32 v230, v230
    v_exp_f32 v231, v231
    v_pk_add_f32 v[184:185], v[200:201], v[202:203]
    v_pk_add_f32 v[186:187], v[204:205], v[206:207]
    v_pk_add_f32 v[188:189], v[208:209], v[210:211]
    s_add_u32 m0, s68, 0x2400
    s_add_u32 s79, s12, 0x12000
    buffer_load_dwordx4 v4, s[36:39], s79 offen lds
    v_pk_add_f32 v[190:191], v[212:213], v[214:215]
    v_pk_add_f32 v[192:193], v[216:217], v[218:219]
    v_pk_add_f32 v[194:195], v[220:221], v[222:223]
    v_pk_add_f32 v[196:197], v[224:225], v[226:227]
    v_pk_add_f32 v[198:199], v[228:229], v[230:231]
    v_pk_add_f32 v[184:185], v[184:185], v[186:187]
    v_pk_add_f32 v[188:189], v[188:189], v[190:191]
    v_pk_add_f32 v[192:193], v[192:193], v[194:195]
    v_pk_add_f32 v[196:197], v[196:197], v[198:199]
    v_add_f32 v184, v184, v185
    v_add_f32 v188, v188, v189
    v_add_f32 v192, v192, v193
    v_add_f32 v196, v196, v197
    v_permlane32_swap_b32 v184, v188
    v_add_f32 v184, v184, v188
    v_rcp_f32 v184, v184
    s_nop 0
    v_mov_b32 v188, v184
    s_nop 1
    v_permlane32_swap_b32 v184, v188
    v_permlane32_swap_b32 v192, v196
    v_add_f32 v192, v192, v196
    s_add_u32 m0, s68, 0x2800
    s_add_u32 s79, s12, 0x14000
    buffer_load_dwordx4 v4, s[36:39], s79 offen lds
    v_rcp_f32 v192, v192
    s_nop 0
    v_mov_b32 v196, v192
    s_nop 1
    v_permlane32_swap_b32 v192, v196
    v_pk_mul_f32 v[200:201], v[200:201], v[184:185] op_sel_hi:[1,0]
    v_pk_mul_f32 v[202:203], v[202:203], v[184:185] op_sel_hi:[1,0]
    v_pk_mul_f32 v[204:205], v[204:205], v[184:185] op_sel_hi:[1,0]
    v_pk_mul_f32 v[206:207], v[206:207], v[184:185] op_sel_hi:[1,0]
    v_pk_mul_f32 v[208:209], v[208:209], v[188:189] op_sel_hi:[1,0]
    v_pk_mul_f32 v[210:211], v[210:211], v[188:189] op_sel_hi:[1,0]
    v_pk_mul_f32 v[212:213], v[212:213], v[188:189] op_sel_hi:[1,0]
    v_pk_mul_f32 v[214:215], v[214:215], v[188:189] op_sel_hi:[1,0]
    v_pk_mul_f32 v[216:217], v[216:217], v[192:193] op_sel_hi:[1,0]
    v_pk_mul_f32 v[218:219], v[218:219], v[192:193] op_sel_hi:[1,0]
    v_pk_mul_f32 v[220:221], v[220:221], v[192:193] op_sel_hi:[1,0]
    v_pk_mul_f32 v[222:223], v[222:223], v[192:193] op_sel_hi:[1,0]
    v_pk_mul_f32 v[224:225], v[224:225], v[196:197] op_sel_hi:[1,0]
    v_pk_mul_f32 v[226:227], v[226:227], v[196:197] op_sel_hi:[1,0]
    v_pk_mul_f32 v[228:229], v[228:229], v[196:197] op_sel_hi:[1,0]
    v_pk_mul_f32 v[230:231], v[230:231], v[196:197] op_sel_hi:[1,0]
    v_cvt_pk_bf16_f32 v144, v200, v201
    s_add_u32 m0, s68, 0x2c00
    s_add_u32 s79, s12, 0x16000
    buffer_load_dwordx4 v4, s[36:39], s79 offen lds
    v_cvt_pk_bf16_f32 v145, v202, v203
    v_cvt_pk_bf16_f32 v146, v204, v205
    v_cvt_pk_bf16_f32 v147, v206, v207
    v_cvt_pk_bf16_f32 v148, v208, v209
    v_cvt_pk_bf16_f32 v149, v210, v211
    v_cvt_pk_bf16_f32 v150, v212, v213
    v_cvt_pk_bf16_f32 v151, v214, v215
    v_cvt_pk_bf16_f32 v152, v216, v217
    v_cvt_pk_bf16_f32 v153, v218, v219
    v_cvt_pk_bf16_f32 v154, v220, v221
    v_cvt_pk_bf16_f32 v155, v222, v223
    v_cvt_pk_bf16_f32 v156, v224, v225
    v_cvt_pk_bf16_f32 v157, v226, v227
    v_cvt_pk_bf16_f32 v158, v228, v229
    v_cvt_pk_bf16_f32 v159, v230, v231
    v_mfma_f32_32x32x16_bf16 v[200:215], v[144:147], v[240:243], 0
    v_mfma_f32_32x32x16_bf16 v[200:215], v[148:151], v[244:247], v[200:215]
    s_mul_i32 s78, s60, 128
    s_add_u32 s78, s78, s88
    s_mul_i32 s79, s78, 11
    v_add_lshl_u32 v9, v0, s79, 7
    s_mov_b64 exec, 0x7ff
    buffer_load_dword v15, v9, s[44:47], 0 offen
    s_mov_b64 exec, -1
    v_mfma_f32_32x32x16_bf16 v[216:231], v[152:155], v[240:243], 0
    v_mfma_f32_32x32x16_bf16 v[216:231], v[156:159], v[244:247], v[216:231]
    s_nop 2
    v_cvt_pk_bf16_f32 v176, v200, v201
    v_cvt_pk_bf16_f32 v177, v202, v203
    v_cvt_pk_bf16_f32 v178, v204, v205
    v_cvt_pk_bf16_f32 v179, v206, v207
    v_cvt_pk_bf16_f32 v180, v208, v209
    v_cvt_pk_bf16_f32 v181, v210, v211
    v_cvt_pk_bf16_f32 v182, v212, v213
    v_cvt_pk_bf16_f32 v183, v214, v215
    v_mfma_f32_32x32x16_bf16 v[144:159], v[176:179], v[160:163], 0
    s_nop 0
    v_mfma_f32_32x32x16_bf16 v[144:159], v[180:183], v[164:167], v[144:159]
    v_cvt_pk_bf16_f32 v184, v216, v217
    v_cvt_pk_bf16_f32 v185, v218, v219
    v_cvt_pk_bf16_f32 v186, v220, v221
    v_cvt_pk_bf16_f32 v187, v222, v223
    v_cvt_pk_bf16_f32 v188, v224, v225
    v_cvt_pk_bf16_f32 v189, v226, v227
    v_cvt_pk_bf16_f32 v190, v228, v229
    v_cvt_pk_bf16_f32 v191, v230, v231
    v_mfma_f32_32x32x16_bf16 v[144:159], v[184:187], v[168:171], v[144:159]
    s_nop 0
    v_mfma_f32_32x32x16_bf16 v[144:159], v[188:191], v[172:175], v[144:159]
    v_pk_add_f32 v[200:201], v[200:201], v[208:209]
    v_pk_add_f32 v[202:203], v[202:203], v[210:211]
    v_pk_add_f32 v[204:205], v[204:205], v[212:213]
    v_pk_add_f32 v[206:207], v[206:207], v[214:215]
    v_pk_add_f32 v[200:201], v[200:201], v[204:205]
    v_pk_add_f32 v[202:203], v[202:203], v[206:207]
    v_pk_add_f32 v[200:201], v[200:201], v[202:203]
    v_add_f32 v192, v200, v201
    v_pk_add_f32 v[216:217], v[216:217], v[224:225]
    v_pk_add_f32 v[218:219], v[218:219], v[226:227]
    v_pk_add_f32 v[220:221], v[220:221], v[228:229]
    v_pk_add_f32 v[222:223], v[222:223], v[230:231]
    v_pk_add_f32 v[216:217], v[216:217], v[220:221]
    v_pk_add_f32 v[218:219], v[218:219], v[222:223]
    v_pk_add_f32 v[216:217], v[216:217], v[218:219]
    v_add_f32 v193, v216, v217
    s_nop 1
    v_permlane32_swap_b32 v192, v193
    v_add_f32 v192, v192, v193
    s_lshl_b32 s73, s64, 3
    v_xor_b32 v6, s73, v0
    v_lshl_add_u32 v6, v6, 2, s68
    ds_write_b32 v6, v192 offset:15872
    v_add_u32 v7, s68, v1
    ds_write_b128 v7, v[148:151] offset:12288
    ds_write_b128 v7, v[152:155] offset:13312
    ds_write_b128 v7, v[156:159] offset:14336
    v_xor_b32 v236, 0x4000, v7
    v_xor_b32 v237, 0x8000, v7
    v_xor_b32 v238, 0xc000, v7
    v_and_b32 v6, 15, v0
    s_lshl_b32 s73, s64, 4
    v_add_lshl_u32 v6, v6, s73, 2
    v_add_u32 v6, 0x3e00, v6
    s_lshl_b32 s73, s63, 16
    s_lshl_b32 s74, s64, 10
    s_add_u32 s73, s73, s74
    s_add_u32 s73, s73, 0x20000
    s_lshl_b32 s74, s62, 12
    s_add_u32 s74, s74, s73
    s_waitcnt lgkmcnt(0)
    s_barrier
    ds_read_b128 v[204:207], v236 offset:12288
    ds_read_b128 v[208:211], v237 offset:13312
    ds_read_b128 v[212:215], v238 offset:14336
    ds_read_b32 v200, v6 offset:0
    ds_read_b32 v201, v6 offset:16384
    ds_read_b32 v202, v6 offset:32768
    ds_read_b32 v203, v6 offset:49152
    v_mov_b32 v151, s65
    s_waitcnt lgkmcnt(0)
    v_pk_add_f32 v[144:145], v[144:145], v[204:205]
    v_pk_add_f32 v[146:147], v[146:147], v[206:207]
    v_pk_add_f32 v[144:145], v[144:145], v[208:209]
    v_pk_add_f32 v[146:147], v[146:147], v[210:211]
    v_pk_add_f32 v[144:145], v[144:145], v[212:213]
    v_pk_add_f32 v[146:147], v[146:147], v[214:215]
    v_pk_add_f32 v[200:201], v[200:201], v[202:203]
    v_cvt_pk_bf16_f32 v148, v144, v145
    v_cvt_pk_bf16_f32 v149, v146, v147
    v_add_f32 v150, v200, v201
    buffer_store_dwordx4 v[148:151], v1, s[52:55], s74 offen sc1
    s_lshl_b32 s73, s62, 2
    s_add_u32 s73, s73, s64
    s_lshl_b32 s73, s73, 6
    s_lshl_b32 s8, s63, 16
    s_add_u32 s8, s8, s73
    s_add_u32 s8, s8, 0x20000
    s_lshl_b32 s3, s63, 12
    s_add_u32 s3, s3, 0x120000
    s_add_u32 s9, s3, s73
    s_lshl_b32 s73, s64, 10
    s_add_u32 s3, s3, s73
    v_lshrrev_b32 v6, 2, v0
    v_mul_u32_u24 v6, 0xfc0, v6
    v_add_u32 v12, v6, v1
    s_mov_b32 s10, 0
    s_sub_u32 s79, s61, 8
    s_cmp_ge_u32 s79, 16
    s_cselect_b32 s50, 0, 0x300000
    s_and_b32 s79, s79, 12
    s_add_u32 s79, s79, s64
    s_lshl_b32 s79, s79, 3
    v_lshrrev_b32 v9, 3, v0
    v_add_lshl_u32 v9, v9, s79, 3
    global_load_dwordx2 a[232:233], v9, s[18:19]
    v_mul_u32_u24 v14, 0xc00, v9
    v_and_b32 v238, 7, v0
    v_lshl_add_u32 v14, v238, 4, v14
    s_and_b32 s89, s61, 3
    s_lshl_b32 s89, s89, 3
    s_add_u32 s89, s89, s60
    s_lshl_b32 s89, s89, 2
    s_add_u32 s89, s89, 64
    s_lshl_b32 s78, s89, 5
    buffer_load_dwordx4 a[240:243], v14, s[48:51], s78 offen nt
    s_add_u32 s78, s78, 6144
    buffer_load_dwordx4 a[244:247], v14, s[48:51], s78 offen nt
    s_add_u32 s78, s78, 6144
    buffer_load_dwordx4 a[248:251], v14, s[48:51], s78 offen nt
    s_add_u32 s78, s78, 6144
    buffer_load_dwordx4 a[252:255], v14, s[48:51], s78 offen nt
    v_add_u32 v11, 0x10000, v11
    v_add_u32 v6, 0, v0
    v_mul_u32_u24 v7, 171, v6
    v_lshrrev_b32 v7, 11, v7
    v_mul_u32_u24 v7, 2560, v7
    v_lshl_add_u32 v236, v6, 4, v7
    v_add_u32 v6, 64, v0
    v_mul_u32_u24 v7, 171, v6
    v_lshrrev_b32 v7, 11, v7
    v_mul_u32_u24 v7, 2560, v7
    v_lshl_add_u32 v237, v6, 4, v7
    v_add_u32 v6, 128, v0
    v_mul_u32_u24 v7, 171, v6
    v_lshrrev_b32 v7, 11, v7
    v_mul_u32_u24 v7, 2560, v7
    v_lshl_add_u32 v239, v6, 4, v7
    s_mul_i32 s5, s63, 3
    s_lshl_b32 s75, s63, 1
    s_add_u32 s75, s75, 11
    s_min_u32 s5, s5, s75
    s_mul_i32 s90, s64, 44032
    s_lshl_b32 s75, s5, 6
    s_add_u32 s90, s90, s75
    s_mul_i32 s91, s64, 3072
    s_waitcnt vmcnt(21)
    s_barrier
    ds_read_b64_tr_b16 v[176:177], v11 offset:0
    ds_read_b64_tr_b16 v[178:179], v11 offset:256
    ds_read_b64_tr_b16 v[180:181], v11 offset:1024
    ds_read_b64_tr_b16 v[182:183], v11 offset:1280
    ds_read_b64_tr_b16 v[184:185], v11 offset:2048
    ds_read_b64_tr_b16 v[186:187], v11 offset:2304
    s_add_u32 m0, s91, 0x10000
    s_add_u32 s79, s90, 0x0
    buffer_load_dwordx4 v236, s[40:43], s79 offen lds
    s_waitcnt lgkmcnt(4)
    v_mfma_f32_32x32x16_bf16 v[160:175], v[176:179], v[16:19], 0
    ds_read_b64_tr_b16 v[188:189], v11 offset:3072
    ds_read_b64_tr_b16 v[190:191], v11 offset:3328
    s_waitcnt lgkmcnt(4)
    v_mfma_f32_32x32x16_bf16 v[160:175], v[180:183], v[20:23], v[160:175]
    ds_read_b64_tr_b16 v[176:177], v11 offset:4096
    ds_read_b64_tr_b16 v[178:179], v11 offset:4352
    s_waitcnt lgkmcnt(4)
    v_mfma_f32_32x32x16_bf16 v[160:175], v[184:187], v[24:27], v[160:175]
    ds_read_b64_tr_b16 v[180:181], v11 offset:5120
    ds_read_b64_tr_b16 v[182:183], v11 offset:5376
    s_waitcnt lgkmcnt(4)
    v_mfma_f32_32x32x16_bf16 v[160:175], v[188:191], v[28:31], v[160:175]
    s_add_u32 m0, s91, 0x10400
    s_add_u32 s79, s90, 0x0
    buffer_load_dwordx4 v237, s[40:43], s79 offen lds
    ds_read_b64_tr_b16 v[184:185], v11 offset:6144
    ds_read_b64_tr_b16 v[186:187], v11 offset:6400
    s_waitcnt lgkmcnt(4)
    v_mfma_f32_32x32x16_bf16 v[160:175], v[176:179], v[32:35], v[160:175]
    ds_read_b64_tr_b16 v[188:189], v11 offset:7168
    ds_read_b64_tr_b16 v[190:191], v11 offset:7424
    s_waitcnt lgkmcnt(4)
    v_mfma_f32_32x32x16_bf16 v[160:175], v[180:183], v[36:39], v[160:175]
    ds_read_b64_tr_b16 v[176:177], v11 offset:8192
    ds_read_b64_tr_b16 v[178:179], v11 offset:8448
    s_waitcnt lgkmcnt(4)
    v_mfma_f32_32x32x16_bf16 v[160:175], v[184:187], v[40:43], v[160:175]
    ds_read_b64_tr_b16 v[180:181], v11 offset:9216
    ds_read_b64_tr_b16 v[182:183], v11 offset:9472
    s_waitcnt lgkmcnt(4)
    v_mfma_f32_32x32x16_bf16 v[160:175], v[188:191], v[44:47], v[160:175]
    s_add_u32 m0, s91, 0x10800
    s_add_u32 s79, s90, 0x0
    buffer_load_dwordx4 v239, s[40:43], s79 offen lds
    ds_read_b64_tr_b16 v[184:185], v11 offset:10240
    ds_read_b64_tr_b16 v[186:187], v11 offset:10496
    s_waitcnt lgkmcnt(4)
    v_mfma_f32_32x32x16_bf16 v[160:175], v[176:179], v[48:51], v[160:175]
    ds_read_b64_tr_b16 v[188:189], v11 offset:11264
    ds_read_b64_tr_b16 v[190:191], v11 offset:11520
    s_waitcnt lgkmcnt(4)
    v_mfma_f32_32x32x16_bf16 v[160:175], v[180:183], v[52:55], v[160:175]
    ds_read_b64_tr_b16 v[176:177], v11 offset:12288
    ds_read_b64_tr_b16 v[178:179], v11 offset:12544
    s_waitcnt lgkmcnt(4)
    v_mfma_f32_32x32x16_bf16 v[160:175], v[184:187], v[56:59], v[160:175]
    ds_read_b64_tr_b16 v[180:181], v11 offset:13312
    ds_read_b64_tr_b16 v[182:183], v11 offset:13568
    s_waitcnt lgkmcnt(4)
    v_mfma_f32_32x32x16_bf16 v[160:175], v[188:191], v[60:63], v[160:175]
    s_add_u32 m0, s91, 0x13000
    s_add_u32 s79, s90, 0x2b000
    buffer_load_dwordx4 v236, s[40:43], s79 offen lds
    ds_read_b64_tr_b16 v[184:185], v11 offset:14336
    ds_read_b64_tr_b16 v[186:187], v11 offset:14592
    s_waitcnt lgkmcnt(4)
    v_mfma_f32_32x32x16_bf16 v[160:175], v[176:179], v[64:67], v[160:175]
    ds_read_b64_tr_b16 v[188:189], v11 offset:15360
    ds_read_b64_tr_b16 v[190:191], v11 offset:15616
    s_waitcnt lgkmcnt(4)
    v_mfma_f32_32x32x16_bf16 v[160:175], v[180:183], v[68:71], v[160:175]
    ds_read_b64_tr_b16 v[176:177], v11 offset:16384
    ds_read_b64_tr_b16 v[178:179], v11 offset:16640
    s_waitcnt lgkmcnt(4)
    v_mfma_f32_32x32x16_bf16 v[160:175], v[184:187], v[72:75], v[160:175]
    ds_read_b64_tr_b16 v[180:181], v11 offset:17408
    ds_read_b64_tr_b16 v[182:183], v11 offset:17664
    s_waitcnt lgkmcnt(4)
    v_mfma_f32_32x32x16_bf16 v[160:175], v[188:191], v[76:79], v[160:175]
    s_add_u32 m0, s91, 0x13400
    s_add_u32 s79, s90, 0x2b000
    buffer_load_dwordx4 v237, s[40:43], s79 offen lds
    ds_read_b64_tr_b16 v[184:185], v11 offset:18432
    ds_read_b64_tr_b16 v[186:187], v11 offset:18688
    s_waitcnt lgkmcnt(4)
    v_mfma_f32_32x32x16_bf16 v[160:175], v[176:179], v[80:83], v[160:175]
    ds_read_b64_tr_b16 v[188:189], v11 offset:19456
    ds_read_b64_tr_b16 v[190:191], v11 offset:19712
    s_waitcnt lgkmcnt(4)
    v_mfma_f32_32x32x16_bf16 v[160:175], v[180:183], v[84:87], v[160:175]
    ds_read_b64_tr_b16 v[176:177], v11 offset:20480
    ds_read_b64_tr_b16 v[178:179], v11 offset:20736
    s_waitcnt lgkmcnt(4)
    v_mfma_f32_32x32x16_bf16 v[160:175], v[184:187], v[88:91], v[160:175]
    ds_read_b64_tr_b16 v[180:181], v11 offset:21504
    ds_read_b64_tr_b16 v[182:183], v11 offset:21760
    s_waitcnt lgkmcnt(4)
    v_mfma_f32_32x32x16_bf16 v[160:175], v[188:191], v[92:95], v[160:175]
    s_add_u32 m0, s91, 0x13800
    s_add_u32 s79, s90, 0x2b000
    buffer_load_dwordx4 v239, s[40:43], s79 offen lds
    ds_read_b64_tr_b16 v[184:185], v11 offset:22528
    ds_read_b64_tr_b16 v[186:187], v11 offset:22784
    s_waitcnt lgkmcnt(4)
    v_mfma_f32_32x32x16_bf16 v[160:175], v[176:179], v[96:99], v[160:175]
    ds_read_b64_tr_b16 v[188:189], v11 offset:23552
    ds_read_b64_tr_b16 v[190:191], v11 offset:23808
    s_waitcnt lgkmcnt(4)
    v_mfma_f32_32x32x16_bf16 v[160:175], v[180:183], v[100:103], v[160:175]
    ds_read_b64_tr_b16 v[176:177], v11 offset:24576
    ds_read_b64_tr_b16 v[178:179], v11 offset:24832
    s_waitcnt lgkmcnt(4)
    v_mfma_f32_32x32x16_bf16 v[160:175], v[184:187], v[104:107], v[160:175]
    ds_read_b64_tr_b16 v[180:181], v11 offset:25600
    ds_read_b64_tr_b16 v[182:183], v11 offset:25856
    s_waitcnt lgkmcnt(4)
    v_mfma_f32_32x32x16_bf16 v[160:175], v[188:191], v[108:111], v[160:175]
    s_add_u32 m0, s91, 0x16000
    s_add_u32 s79, s90, 0x56000
    buffer_load_dwordx4 v236, s[40:43], s79 offen lds
    ds_read_b64_tr_b16 v[184:185], v11 offset:26624
    ds_read_b64_tr_b16 v[186:187], v11 offset:26880
    s_waitcnt lgkmcnt(4)
    v_mfma_f32_32x32x16_bf16 v[160:175], v[176:179], v[112:115], v[160:175]
    ds_read_b64_tr_b16 v[188:189], v11 offset:27648
    ds_read_b64_tr_b16 v[190:191], v11 offset:27904
    s_waitcnt lgkmcnt(4)
    v_mfma_f32_32x32x16_bf16 v[160:175], v[180:183], v[116:119], v[160:175]
    ds_read_b64_tr_b16 v[176:177], v11 offset:28672
    ds_read_b64_tr_b16 v[178:179], v11 offset:28928
    s_waitcnt lgkmcnt(4)
    v_mfma_f32_32x32x16_bf16 v[160:175], v[184:187], v[120:123], v[160:175]
    ds_read_b64_tr_b16 v[180:181], v11 offset:29696
    ds_read_b64_tr_b16 v[182:183], v11 offset:29952
    s_waitcnt lgkmcnt(4)
    v_mfma_f32_32x32x16_bf16 v[160:175], v[188:191], v[124:127], v[160:175]
    s_add_u32 m0, s91, 0x16400
    s_add_u32 s79, s90, 0x56000
    buffer_load_dwordx4 v237, s[40:43], s79 offen lds
    ds_read_b64_tr_b16 v[184:185], v11 offset:30720
    ds_read_b64_tr_b16 v[186:187], v11 offset:30976
    s_waitcnt lgkmcnt(4)
    v_mfma_f32_32x32x16_bf16 v[160:175], v[176:179], v[128:131], v[160:175]
    ds_read_b64_tr_b16 v[188:189], v11 offset:31744
    ds_read_b64_tr_b16 v[190:191], v11 offset:32000
    s_waitcnt lgkmcnt(4)
    v_mfma_f32_32x32x16_bf16 v[160:175], v[180:183], v[132:135], v[160:175]
    s_waitcnt lgkmcnt(2)
    v_mfma_f32_32x32x16_bf16 v[160:175], v[184:187], v[136:139], v[160:175]
    s_waitcnt lgkmcnt(0)
    v_mfma_f32_32x32x16_bf16 v[160:175], v[188:191], v[140:143], v[160:175]
    s_add_u32 m0, s91, 0x16800
    s_add_u32 s79, s90, 0x56000
    buffer_load_dwordx4 v239, s[40:43], s79 offen lds
    buffer_load_dwordx4 v[144:147], v12, s[52:55], s8 offen sc1
    s_waitcnt lgkmcnt(0)
    s_barrier
    s_and_b32 s4, s63, 7
    s_lshl_b32 s4, s4, 1
    s_lshr_b32 s75, s64, 1
    s_add_u32 s4, s4, s75
    s_lshr_b32 s6, s63, 3
    s_lshl_b32 s6, s6, 1
    s_xor_b32 s75, s64, s63
    s_and_b32 s75, s75, 1
    s_add_u32 s6, s6, s75
    s_lshl_b32 s75, s62, 2
    s_add_u32 s75, s75, s6
    s_lshl_b32 s75, s75, 15
    s_lshl_b32 s76, s4, 6
    s_add_u32 s7, s75, s76
    v_lshrrev_b32 v6, 4, v0
    v_xor_b32 v6, v6, v0
    v_and_b32 v6, 3, v6
    v_lshrrev_b32 v7, 2, v0
    v_lshlrev_b32 v13, 10, v7
    v_lshl_add_u32 v13, v6, 4, v13
    v_and_b32 v7, 3, v7
    v_and_b32 v6, 31, v0
    v_lshlrev_b32 v6, 6, v6
    v_lshl_add_u32 v6, v7, 4, v6
    v_lshrrev_b32 v7, 5, v0
    v_lshl_add_u32 v14, v7, 3, v6
    v_cvt_pk_bf16_f32 v176, v160, v161
    v_cvt_pk_bf16_f32 v177, v162, v163
    v_cvt_pk_bf16_f32 v178, v164, v165
    v_cvt_pk_bf16_f32 v179, v166, v167
    v_cvt_pk_bf16_f32 v180, v168, v169
    v_cvt_pk_bf16_f32 v181, v170, v171
    v_cvt_pk_bf16_f32 v182, v172, v173
    v_cvt_pk_bf16_f32 v183, v174, v175
    v_mfma_f32_32x32x16_bf16 v[184:199], v[248:251], v[176:179], 0
    s_nop 0
    v_mfma_f32_32x32x16_bf16 v[184:199], v[252:255], v[180:183], v[184:199]
    s_nop 11
    v_max3_f32 v232, v184, v185, v186
    v_max3_f32 v232, v232, v187, v188
    v_max3_f32 v232, v232, v189, v190
    s_add_u32 m0, s91, 0x19000
    s_add_u32 s79, s90, 0x81000
    buffer_load_dwordx4 v236, s[40:43], s79 offen lds
    v_max_f32 v232, v232, v191
    v_min3_f32 v234, v184, v185, v186
    v_min3_f32 v234, v234, v187, v188
    v_min3_f32 v234, v234, v189, v190
    v_min_f32 v234, v234, v191
    v_max3_f32 v233, v192, v193, v194
    v_max3_f32 v233, v233, v195, v196
    v_max3_f32 v233, v233, v197, v198
    v_max_f32 v233, v233, v199
    v_min3_f32 v235, v192, v193, v194
    v_min3_f32 v235, v235, v195, v196
    v_min3_f32 v235, v235, v197, v198
    v_min_f32 v235, v235, v199
    v_permlane32_swap_b32 v232, v233
    v_max_f32 v232, v232, v233
    v_mul_f32 v232, s69, v232
    v_mov_b32 v233, v232
    s_nop 1
    v_permlane32_swap_b32 v232, v233
    v_permlane32_swap_b32 v234, v235
    v_min_f32 v234, v234, v235
    v_mul_f32 v234, s69, v234
    v_mov_b32 v235, v234
    s_nop 1
    v_permlane32_swap_b32 v234, v235
    s_add_u32 m0, s91, 0x19400
    s_add_u32 s79, s90, 0x81000
    buffer_load_dwordx4 v237, s[40:43], s79 offen lds
    s_cmp_lg_u32 s10, 0
    s_cbranch_scc1 k2skip_11
    s_waitcnt vmcnt(2)
    v_cmp_ne_u32 vcc, s65, v147
    s_cbranch_vccnz k2no_10
    v_lshlrev_b32 v116, 16, v144
    v_and_b32 v117, s71, v144
    v_lshlrev_b32 v118, 16, v145
    v_and_b32 v119, s71, v145
    v_add_f32_dpp v146, v146, v146 row_ror:4 row_mask:0xf bank_mask:0xf
    v_add_f32_dpp v116, v116, v116 row_ror:4 row_mask:0xf bank_mask:0xf
    v_add_f32_dpp v117, v117, v117 row_ror:4 row_mask:0xf bank_mask:0xf
    v_add_f32_dpp v118, v118, v118 row_ror:4 row_mask:0xf bank_mask:0xf
    v_add_f32_dpp v119, v119, v119 row_ror:4 row_mask:0xf bank_mask:0xf
    v_add_f32_dpp v146, v146, v146 row_ror:8 row_mask:0xf bank_mask:0xf
    v_add_f32_dpp v116, v116, v116 row_ror:8 row_mask:0xf bank_mask:0xf
    v_add_f32_dpp v117, v117, v117 row_ror:8 row_mask:0xf bank_mask:0xf
    v_add_f32_dpp v118, v118, v118 row_ror:8 row_mask:0xf bank_mask:0xf
    v_add_f32_dpp v119, v119, v119 row_ror:8 row_mask:0xf bank_mask:0xf
    v_mov_b32 v120, v146
    v_permlane16_swap_b32 v116, v117
    v_permlane16_swap_b32 v118, v119
    v_permlane16_swap_b32 v146, v120
    v_add_f32 v116, v116, v117
    v_add_f32 v118, v118, v119
    v_add_f32 v146, v146, v120
    v_mov_b32 v120, v146
    v_permlane32_swap_b32 v116, v118
    v_add_f32 v116, v116, v118
    v_permlane32_swap_b32 v146, v120
    v_mov_b32 v117, v116
    v_add_f32 v146, v146, v120
    s_nop 0
    v_permlane16_swap_b32 v116, v117
    v_cvt_pk_bf16_f32 v144, v116, v117
    v_cvt_pk_bf16_f32 v145, v116, v117
    s_nop 1
    v_permlane32_swap_b32 v144, v145
    s_mov_b64 exec, 0xf
    buffer_store_dwordx4 v[144:147], v1, s[52:55], s9 offen sc1
    s_mov_b64 exec, -1
    s_mov_b32 s10, 1
    s_branch k2skip_11
k2no_10:
    buffer_load_dwordx4 v[112:115], v12, s[52:55], s8 offen sc1
k2skip_11:
    v_fma_f32 v200, v184, s69, -v232
    v_fma_f32 v208, -v184, s69, v234
    v_fma_f32 v201, v185, s69, -v232
    v_fma_f32 v209, -v185, s69, v234
    v_fma_f32 v202, v186, s69, -v232
    v_fma_f32 v210, -v186, s69, v234
    v_fma_f32 v203, v187, s69, -v232
    v_fma_f32 v211, -v187, s69, v234
    v_fma_f32 v204, v188, s69, -v232
    v_fma_f32 v212, -v188, s69, v234
    v_fma_f32 v205, v189, s69, -v232
    v_fma_f32 v213, -v189, s69, v234
    v_fma_f32 v206, v190, s69, -v232
    v_fma_f32 v214, -v190, s69, v234
    v_fma_f32 v207, v191, s69, -v232
    v_fma_f32 v215, -v191, s69, v234
    v_fma_f32 v216, v192, s69, -v233
    v_fma_f32 v224, -v192, s69, v235
    v_fma_f32 v217, v193, s69, -v233
    v_fma_f32 v225, -v193, s69, v235
    v_fma_f32 v218, v194, s69, -v233
    v_fma_f32 v226, -v194, s69, v235
    v_fma_f32 v219, v195, s69, -v233
    s_add_u32 m0, s91, 0x19800
    s_add_u32 s79, s90, 0x81000
    buffer_load_dwordx4 v239, s[40:43], s79 offen lds
    v_fma_f32 v227, -v195, s69, v235
    v_fma_f32 v220, v196, s69, -v233
    v_fma_f32 v228, -v196, s69, v235
    v_fma_f32 v221, v197, s69, -v233
    v_fma_f32 v229, -v197, s69, v235
    v_fma_f32 v222, v198, s69, -v233
    v_fma_f32 v230, -v198, s69, v235
    v_fma_f32 v223, v199, s69, -v233
    v_fma_f32 v231, -v199, s69, v235
    v_exp_f32 v200, v200
    v_exp_f32 v201, v201
    v_exp_f32 v202, v202
    v_exp_f32 v203, v203
    s_add_u32 m0, s91, 0x1c000
    s_add_u32 s79, s90, 0xac000
    buffer_load_dwordx4 v236, s[40:43], s79 offen lds
    v_exp_f32 v204, v204
    v_exp_f32 v205, v205
    v_exp_f32 v206, v206
    v_exp_f32 v207, v207
    v_exp_f32 v208, v208
    v_exp_f32 v209, v209
    s_add_u32 m0, s91, 0x1c400
    s_add_u32 s79, s90, 0xac000
    buffer_load_dwordx4 v237, s[40:43], s79 offen lds
    v_exp_f32 v210, v210
    v_exp_f32 v211, v211
    v_exp_f32 v212, v212
    v_exp_f32 v213, v213
    v_exp_f32 v214, v214
    v_exp_f32 v215, v215
    s_add_u32 m0, s91, 0x1c800
    s_add_u32 s79, s90, 0xac000
    buffer_load_dwordx4 v239, s[40:43], s79 offen lds
    v_exp_f32 v216, v216
    s_waitcnt vmcnt(23)
    ds_read_b64_tr_b16 a[0:1], v2 offset:0
    ds_read_b64_tr_b16 a[4:5], v3 offset:0
    ds_read_b64_tr_b16 a[2:3], v2 offset:1024
    ds_read_b64_tr_b16 a[6:7], v3 offset:1024
    ds_read_b64_tr_b16 a[8:9], v2 offset:2048
    ds_read_b64_tr_b16 a[12:13], v3 offset:2048
    ds_read_b64_tr_b16 a[10:11], v2 offset:3072
    ds_read_b64_tr_b16 a[14:15], v3 offset:3072
    ds_read_b64_tr_b16 a[16:17], v2 offset:4096
    ds_read_b64_tr_b16 a[20:21], v3 offset:4096
    ds_read_b64_tr_b16 a[18:19], v2 offset:5120
    ds_read_b64_tr_b16 a[22:23], v3 offset:5120
    ds_read_b64_tr_b16 a[24:25], v2 offset:6144
    ds_read_b64_tr_b16 a[28:29], v3 offset:6144
    ds_read_b64_tr_b16 a[26:27], v2 offset:7168
    ds_read_b64_tr_b16 a[30:31], v3 offset:7168
    ds_read_b64_tr_b16 a[32:33], v2 offset:8192
    ds_read_b64_tr_b16 a[36:37], v3 offset:8192
    ds_read_b64_tr_b16 a[34:35], v2 offset:9216
    ds_read_b64_tr_b16 a[38:39], v3 offset:9216
    ds_read_b64_tr_b16 a[40:41], v2 offset:10240
    ds_read_b64_tr_b16 a[44:45], v3 offset:10240
    ds_read_b64_tr_b16 a[42:43], v2 offset:11264
    ds_read_b64_tr_b16 a[46:47], v3 offset:11264
    s_waitcnt lgkmcnt(0)
    v_exp_f32 v217, v217
    v_exp_f32 v218, v218
    v_exp_f32 v219, v219
    v_exp_f32 v220, v220
    v_exp_f32 v221, v221
    v_exp_f32 v222, v222
    s_add_u32 m0, s68, 0x0
    s_add_u32 s79, s12, 0x18000
    buffer_load_dwordx4 v4, s[36:39], s79 offen lds
    v_exp_f32 v223, v223
    v_exp_f32 v224, v224
    v_exp_f32 v225, v225
    v_exp_f32 v226, v226
    v_exp_f32 v227, v227
    v_exp_f32 v228, v228
    s_add_u32 m0, s68, 0x400
    s_add_u32 s79, s12, 0x1a000
    buffer_load_dwordx4 v4, s[36:39], s79 offen lds
    v_exp_f32 v229, v229
    v_exp_f32 v230, v230
    v_exp_f32 v231, v231
    s_cmp_lg_u32 s10, 0
    s_cbranch_scc1 k2skip_13
    s_waitcnt vmcnt(6)
    v_cmp_ne_u32 vcc, s65, v115
    s_cbranch_vccnz k2no_12
    v_lshlrev_b32 v116, 16, v112
    v_and_b32 v117, s71, v112
    v_lshlrev_b32 v118, 16, v113
    v_and_b32 v119, s71, v113
    v_add_f32_dpp v114, v114, v114 row_ror:4 row_mask:0xf bank_mask:0xf
    v_add_f32_dpp v116, v116, v116 row_ror:4 row_mask:0xf bank_mask:0xf
    v_add_f32_dpp v117, v117, v117 row_ror:4 row_mask:0xf bank_mask:0xf
    v_add_f32_dpp v118, v118, v118 row_ror:4 row_mask:0xf bank_mask:0xf
    v_add_f32_dpp v119, v119, v119 row_ror:4 row_mask:0xf bank_mask:0xf
    v_add_f32_dpp v114, v114, v114 row_ror:8 row_mask:0xf bank_mask:0xf
    v_add_f32_dpp v116, v116, v116 row_ror:8 row_mask:0xf bank_mask:0xf
    v_add_f32_dpp v117, v117, v117 row_ror:8 row_mask:0xf bank_mask:0xf
    v_add_f32_dpp v118, v118, v118 row_ror:8 row_mask:0xf bank_mask:0xf
    v_add_f32_dpp v119, v119, v119 row_ror:8 row_mask:0xf bank_mask:0xf
    v_mov_b32 v120, v114
    v_permlane16_swap_b32 v116, v117
    v_permlane16_swap_b32 v118, v119
    v_permlane16_swap_b32 v114, v120
    v_add_f32 v116, v116, v117
    v_add_f32 v118, v118, v119
    v_add_f32 v114, v114, v120
    v_mov_b32 v120, v114
    v_permlane32_swap_b32 v116, v118
    v_add_f32 v116, v116, v118
    v_permlane32_swap_b32 v114, v120
    v_mov_b32 v117, v116
    v_add_f32 v114, v114, v120
    s_nop 0
    v_permlane16_swap_b32 v116, v117
    v_cvt_pk_bf16_f32 v112, v116, v117
    v_cvt_pk_bf16_f32 v113, v116, v117
    s_nop 1
    v_permlane32_swap_b32 v112, v113
    s_mov_b64 exec, 0xf
    buffer_store_dwordx4 v[112:115], v1, s[52:55], s9 offen sc1
    s_mov_b64 exec, -1
    s_mov_b32 s10, 1
    s_branch k2skip_13
k2no_12:
    buffer_load_dwordx4 v[112:115], v12, s[52:55], s8 offen sc1
k2skip_13:
    v_pk_add_f32 v[184:185], v[200:201], v[202:203]
    v_pk_add_f32 v[186:187], v[204:205], v[206:207]
    v_pk_add_f32 v[188:189], v[208:209], v[210:211]
    v_pk_add_f32 v[190:191], v[212:213], v[214:215]
    v_pk_add_f32 v[192:193], v[216:217], v[218:219]
    v_pk_add_f32 v[194:195], v[220:221], v[222:223]
    v_pk_add_f32 v[196:197], v[224:225], v[226:227]
    v_pk_add_f32 v[198:199], v[228:229], v[230:231]
    v_pk_add_f32 v[184:185], v[184:185], v[186:187]
    v_pk_add_f32 v[188:189], v[188:189], v[190:191]
    v_pk_add_f32 v[192:193], v[192:193], v[194:195]
    s_add_u32 m0, s68, 0x800
    s_add_u32 s79, s12, 0x1c000
    buffer_load_dwordx4 v4, s[36:39], s79 offen lds
    v_pk_add_f32 v[196:197], v[196:197], v[198:199]
    v_add_f32 v184, v184, v185
    v_add_f32 v188, v188, v189
    v_add_f32 v192, v192, v193
    v_add_f32 v196, v196, v197
    v_permlane32_swap_b32 v184, v188
    v_add_f32 v184, v184, v188
    v_rcp_f32 v184, v184
    s_nop 0
    v_mov_b32 v188, v184
    s_nop 1
    v_permlane32_swap_b32 v184, v188
    v_permlane32_swap_b32 v192, v196
    v_add_f32 v192, v192, v196
    v_rcp_f32 v192, v192
    s_nop 0
    v_mov_b32 v196, v192
    s_nop 1
    v_permlane32_swap_b32 v192, v196
    s_cmp_lg_u32 s10, 0
    s_cbranch_scc1 k2skip_15
    s_waitcnt vmcnt(1)
    v_cmp_ne_u32 vcc, s65, v115
    s_cbranch_vccnz k2no_14
    v_lshlrev_b32 v116, 16, v112
    v_and_b32 v117, s71, v112
    v_lshlrev_b32 v118, 16, v113
    v_and_b32 v119, s71, v113
    v_add_f32_dpp v114, v114, v114 row_ror:4 row_mask:0xf bank_mask:0xf
    v_add_f32_dpp v116, v116, v116 row_ror:4 row_mask:0xf bank_mask:0xf
    v_add_f32_dpp v117, v117, v117 row_ror:4 row_mask:0xf bank_mask:0xf
    v_add_f32_dpp v118, v118, v118 row_ror:4 row_mask:0xf bank_mask:0xf
    v_add_f32_dpp v119, v119, v119 row_ror:4 row_mask:0xf bank_mask:0xf
    v_add_f32_dpp v114, v114, v114 row_ror:8 row_mask:0xf bank_mask:0xf
    v_add_f32_dpp v116, v116, v116 row_ror:8 row_mask:0xf bank_mask:0xf
    v_add_f32_dpp v117, v117, v117 row_ror:8 row_mask:0xf bank_mask:0xf
    v_add_f32_dpp v118, v118, v118 row_ror:8 row_mask:0xf bank_mask:0xf
    v_add_f32_dpp v119, v119, v119 row_ror:8 row_mask:0xf bank_mask:0xf
    v_mov_b32 v120, v114
    v_permlane16_swap_b32 v116, v117
    v_permlane16_swap_b32 v118, v119
    v_permlane16_swap_b32 v114, v120
    v_add_f32 v116, v116, v117
    v_add_f32 v118, v118, v119
    v_add_f32 v114, v114, v120
    v_mov_b32 v120, v114
    v_permlane32_swap_b32 v116, v118
    v_add_f32 v116, v116, v118
    v_permlane32_swap_b32 v114, v120
    v_mov_b32 v117, v116
    v_add_f32 v114, v114, v120
    s_nop 0
    v_permlane16_swap_b32 v116, v117
    v_cvt_pk_bf16_f32 v112, v116, v117
    v_cvt_pk_bf16_f32 v113, v116, v117
    s_nop 1
    v_permlane32_swap_b32 v112, v113
    s_mov_b64 exec, 0xf
    buffer_store_dwordx4 v[112:115], v1, s[52:55], s9 offen sc1
    s_mov_b64 exec, -1
    s_mov_b32 s10, 1
k2no_14:
k2skip_15:
    v_pk_mul_f32 v[200:201], v[200:201], v[184:185] op_sel_hi:[1,0]
    v_pk_mul_f32 v[202:203], v[202:203], v[184:185] op_sel_hi:[1,0]
    s_add_u32 m0, s68, 0xc00
    s_add_u32 s79, s12, 0x1e000
    buffer_load_dwordx4 v4, s[36:39], s79 offen lds
    v_pk_mul_f32 v[204:205], v[204:205], v[184:185] op_sel_hi:[1,0]
    v_pk_mul_f32 v[206:207], v[206:207], v[184:185] op_sel_hi:[1,0]
    v_pk_mul_f32 v[208:209], v[208:209], v[188:189] op_sel_hi:[1,0]
    v_pk_mul_f32 v[210:211], v[210:211], v[188:189] op_sel_hi:[1,0]
    v_pk_mul_f32 v[212:213], v[212:213], v[188:189] op_sel_hi:[1,0]
    v_pk_mul_f32 v[214:215], v[214:215], v[188:189] op_sel_hi:[1,0]
    v_pk_mul_f32 v[216:217], v[216:217], v[192:193] op_sel_hi:[1,0]
    v_pk_mul_f32 v[218:219], v[218:219], v[192:193] op_sel_hi:[1,0]
    v_pk_mul_f32 v[220:221], v[220:221], v[192:193] op_sel_hi:[1,0]
    v_pk_mul_f32 v[222:223], v[222:223], v[192:193] op_sel_hi:[1,0]
    v_pk_mul_f32 v[224:225], v[224:225], v[196:197] op_sel_hi:[1,0]
    v_pk_mul_f32 v[226:227], v[226:227], v[196:197] op_sel_hi:[1,0]
    v_pk_mul_f32 v[228:229], v[228:229], v[196:197] op_sel_hi:[1,0]
    v_pk_mul_f32 v[230:231], v[230:231], v[196:197] op_sel_hi:[1,0]
    v_cvt_pk_bf16_f32 v144, v200, v201
    v_cvt_pk_bf16_f32 v145, v202, v203
    v_cvt_pk_bf16_f32 v146, v204, v205
    v_cvt_pk_bf16_f32 v147, v206, v207
    v_cvt_pk_bf16_f32 v148, v208, v209
    v_cvt_pk_bf16_f32 v149, v210, v211
    v_cvt_pk_bf16_f32 v150, v212, v213
    v_cvt_pk_bf16_f32 v151, v214, v215
    v_cvt_pk_bf16_f32 v152, v216, v217
    v_cvt_pk_bf16_f32 v153, v218, v219
    v_cvt_pk_bf16_f32 v154, v220, v221
    v_cvt_pk_bf16_f32 v155, v222, v223
    v_cvt_pk_bf16_f32 v156, v224, v225
    v_cvt_pk_bf16_f32 v157, v226, v227
    v_cvt_pk_bf16_f32 v158, v228, v229
    v_cvt_pk_bf16_f32 v159, v230, v231
    s_add_u32 m0, s68, 0x3000
    s_add_u32 s79, s7, 0x0
    buffer_load_dwordx4 v13, s[28:31], s79 offen lds
    s_add_u32 m0, s68, 0x3400
    s_add_u32 s79, s7, 0x4000
    buffer_load_dwordx4 v13, s[28:31], s79 offen lds
    v_and_b32 v6, 31, v0
    v_lshlrev_b32 v6, 4, v6
    v_and_b32 v7, 32, v0
    v_lshlrev_b32 v7, 8, v7
    v_sub_u32 v88, v6, v7
    v_add_u32 v88, 0x4000, v88
    v_lshlrev_b32 v89, 2, v0
    v_lshlrev_b32 v6, 3, v0
    v_bfe_u32 v90, s65, v6, 8
    s_lshl_b32 s97, s64, 9
    s_add_u32 s97, s97, 0x14000
    s_lshl_b32 s75, s64, 2
    s_lshr_b32 s75, 0x1320, s75
    s_and_b32 s75, s75, 3
    s_lshl_b32 s75, s75, 5
    s_and_b32 s76, s63, 7
    s_add_u32 s75, s75, s76
    s_lshl_b32 s75, s75, 8
    s_add_u32 s89, s75, 0x14000
    s_cmp_lg_u32 s10, 0
    s_cbranch_scc1 k2done_16
    buffer_load_dwordx4 v[112:115], v12, s[52:55], s8 offen sc1
    s_sleep 2
    buffer_load_dwordx4 v[124:127], v12, s[52:55], s8 offen sc1
poll_k2_17:
    s_waitcnt vmcnt(1)
    v_cmp_ne_u32 vcc, s65, v115
    s_cbranch_vccz got_k2_19
    buffer_load_dwordx4 v[112:115], v12, s[52:55], s8 offen sc1
    s_waitcnt vmcnt(1)
    v_cmp_ne_u32 vcc, s65, v127
    s_cbranch_vccz got_k2_20
    buffer_load_dwordx4 v[124:127], v12, s[52:55], s8 offen sc1
    s_sub_u32 s67, s67, 1
    s_cbranch_scc0 poll_k2_17
    s_endpgm
got_k2_19:
    v_lshlrev_b32 v116, 16, v112
    v_and_b32 v117, s71, v112
    v_lshlrev_b32 v118, 16, v113
    v_and_b32 v119, s71, v113
    v_add_f32_dpp v114, v114, v114 row_ror:4 row_mask:0xf bank_mask:0xf
    v_add_f32_dpp v116, v116, v116 row_ror:4 row_mask:0xf bank_mask:0xf
    v_add_f32_dpp v117, v117, v117 row_ror:4 row_mask:0xf bank_mask:0xf
    v_add_f32_dpp v118, v118, v118 row_ror:4 row_mask:0xf bank_mask:0xf
    v_add_f32_dpp v119, v119, v119 row_ror:4 row_mask:0xf bank_mask:0xf
    v_add_f32_dpp v114, v114, v114 row_ror:8 row_mask:0xf bank_mask:0xf
    v_add_f32_dpp v116, v116, v116 row_ror:8 row_mask:0xf bank_mask:0xf
    v_add_f32_dpp v117, v117, v117 row_ror:8 row_mask:0xf bank_mask:0xf
    v_add_f32_dpp v118, v118, v118 row_ror:8 row_mask:0xf bank_mask:0xf
    v_add_f32_dpp v119, v119, v119 row_ror:8 row_mask:0xf bank_mask:0xf
    v_mov_b32 v120, v114
    v_permlane16_swap_b32 v116, v117
    v_permlane16_swap_b32 v118, v119
    v_permlane16_swap_b32 v114, v120
    v_add_f32 v116, v116, v117
    v_add_f32 v118, v118, v119
    v_add_f32 v114, v114, v120
    v_mov_b32 v120, v114
    v_permlane32_swap_b32 v116, v118
    v_add_f32 v116, v116, v118
    v_permlane32_swap_b32 v114, v120
    v_mov_b32 v117, v116
    v_add_f32 v114, v114, v120
    s_nop 0
    v_permlane16_swap_b32 v116, v117
    v_cvt_pk_bf16_f32 v112, v116, v117
    v_cvt_pk_bf16_f32 v113, v116, v117
    s_nop 1
    v_permlane32_swap_b32 v112, v113
    s_mov_b64 exec, 0xf
    buffer_store_dwordx4 v[112:115], v1, s[52:55], s9 offen sc1
    s_mov_b64 exec, -1
    s_branch done_k2_18
got_k2_20:
    v_lshlrev_b32 v116, 16, v124
    v_and_b32 v117, s71, v124
    v_lshlrev_b32 v118, 16, v125
    v_and_b32 v119, s71, v125
    v_add_f32_dpp v126, v126, v126 row_ror:4 row_mask:0xf bank_mask:0xf
    v_add_f32_dpp v116, v116, v116 row_ror:4 row_mask:0xf bank_mask:0xf
    v_add_f32_dpp v117, v117, v117 row_ror:4 row_mask:0xf bank_mask:0xf
    v_add_f32_dpp v118, v118, v118 row_ror:4 row_mask:0xf bank_mask:0xf
    v_add_f32_dpp v119, v119, v119 row_ror:4 row_mask:0xf bank_mask:0xf
    v_add_f32_dpp v126, v126, v126 row_ror:8 row_mask:0xf bank_mask:0xf
    v_add_f32_dpp v116, v116, v116 row_ror:8 row_mask:0xf bank_mask:0xf
    v_add_f32_dpp v117, v117, v117 row_ror:8 row_mask:0xf bank_mask:0xf
    v_add_f32_dpp v118, v118, v118 row_ror:8 row_mask:0xf bank_mask:0xf
    v_add_f32_dpp v119, v119, v119 row_ror:8 row_mask:0xf bank_mask:0xf
    v_mov_b32 v120, v126
    v_permlane16_swap_b32 v116, v117
    v_permlane16_swap_b32 v118, v119
    v_permlane16_swap_b32 v126, v120
    v_add_f32 v116, v116, v117
    v_add_f32 v118, v118, v119
    v_add_f32 v126, v126, v120
    v_mov_b32 v120, v126
    v_permlane32_swap_b32 v116, v118
    v_add_f32 v116, v116, v118
    v_permlane32_swap_b32 v126, v120
    v_mov_b32 v117, v116
    v_add_f32 v126, v126, v120
    s_nop 0
    v_permlane16_swap_b32 v116, v117
    v_cvt_pk_bf16_f32 v124, v116, v117
    v_cvt_pk_bf16_f32 v125, v116, v117
    s_nop 1
    v_permlane32_swap_b32 v124, v125
    s_mov_b64 exec, 0xf
    buffer_store_dwordx4 v[124:127], v1, s[52:55], s9 offen sc1
    s_mov_b64 exec, -1
done_k2_18:
k2done_16:
    buffer_load_dwordx4 v[96:99], v1, s[52:55], s3 offen sc1
    s_sub_u32 s75, s61, 8
    s_cmp_ge_u32 s75, 16
    s_cbranch_scc1 L_nopub2
    s_waitcnt vmcnt(23)
    v_accvgpr_read_b32 v192, a232
    v_accvgpr_read_b32 v193, a233
    v_lshlrev_b32 v216, 16, v192
    v_and_b32 v217, s71, v192
    v_lshlrev_b32 v218, 16, v193
    v_and_b32 v219, s71, v193
    v_mul_f32 v220, 0xbfb8aa3b, v216
    v_mul_f32 v221, 0xbfb8aa3b, v217
    v_mul_f32 v222, 0xbfb8aa3b, v218
    v_mul_f32 v223, 0xbfb8aa3b, v219
    v_exp_f32 v220, v220
    v_exp_f32 v221, v221
    v_exp_f32 v222, v222
    v_exp_f32 v223, v223
    v_add_f32 v220, 1.0, v220
    v_add_f32 v221, 1.0, v221
    v_add_f32 v222, 1.0, v222
    v_add_f32 v223, 1.0, v223
    v_rcp_f32 v220, v220
    v_rcp_f32 v221, v221
    v_rcp_f32 v222, v222
    v_rcp_f32 v223, v223
    v_mul_f32 v216, v216, v220
    v_mul_f32 v217, v217, v221
    v_mul_f32 v218, v218, v222
    v_mul_f32 v219, v219, v223
    v_cvt_pk_bf16_f32 v208, v216, 0
    v_cvt_pk_bf16_f32 v212, 0, v216
    v_cvt_pk_bf16_f32 v209, v217, 0
    v_cvt_pk_bf16_f32 v213, 0, v217
    v_cvt_pk_bf16_f32 v210, v218, 0
    v_cvt_pk_bf16_f32 v214, 0, v218
    v_cvt_pk_bf16_f32 v211, v219, 0
    v_cvt_pk_bf16_f32 v215, 0, v219
    v_accvgpr_read_b32 v192, a240
    v_accvgpr_read_b32 v193, a241
    v_accvgpr_read_b32 v194, a242
    v_accvgpr_read_b32 v195, a243
    v_accvgpr_read_b32 v196, a244
    v_accvgpr_read_b32 v197, a245
    v_accvgpr_read_b32 v198, a246
    v_accvgpr_read_b32 v199, a247
    v_accvgpr_read_b32 v200, a248
    v_accvgpr_read_b32 v201, a249
    v_accvgpr_read_b32 v202, a250
    v_accvgpr_read_b32 v203, a251
    v_accvgpr_read_b32 v204, a252
    v_accvgpr_read_b32 v205, a253
    v_accvgpr_read_b32 v206, a254
    v_accvgpr_read_b32 v207, a255
    v_dot2_f32_bf16 v216, v192, v208, 0
    v_dot2_f32_bf16 v217, v192, v212, 0
    v_dot2_f32_bf16 v218, v193, v208, 0
    v_dot2_f32_bf16 v219, v193, v212, 0
    v_dot2_f32_bf16 v220, v194, v208, 0
    v_dot2_f32_bf16 v221, v194, v212, 0
    v_dot2_f32_bf16 v222, v195, v208, 0
    v_dot2_f32_bf16 v223, v195, v212, 0
    v_dot2_f32_bf16 v216, v196, v209, v216
    v_dot2_f32_bf16 v217, v196, v213, v217
    v_dot2_f32_bf16 v218, v197, v209, v218
    v_dot2_f32_bf16 v219, v197, v213, v219
    v_dot2_f32_bf16 v220, v198, v209, v220
    v_dot2_f32_bf16 v221, v198, v213, v221
    v_dot2_f32_bf16 v222, v199, v209, v222
    v_dot2_f32_bf16 v223, v199, v213, v223
    v_dot2_f32_bf16 v216, v200, v210, v216
    v_dot2_f32_bf16 v217, v200, v214, v217
    v_dot2_f32_bf16 v218, v201, v210, v218
    v_dot2_f32_bf16 v219, v201, v214, v219
    v_dot2_f32_bf16 v220, v202, v210, v220
    v_dot2_f32_bf16 v221, v202, v214, v221
    v_dot2_f32_bf16 v222, v203, v210, v222
    v_dot2_f32_bf16 v223, v203, v214, v223
    v_dot2_f32_bf16 v216, v204, v211, v216
    v_dot2_f32_bf16 v217, v204, v215, v217
    v_dot2_f32_bf16 v218, v205, v211, v218
    v_dot2_f32_bf16 v219, v205, v215, v219
    v_dot2_f32_bf16 v220, v206, v211, v220
    v_dot2_f32_bf16 v221, v206, v215, v221
    v_dot2_f32_bf16 v222, v207, v211, v222
    v_dot2_f32_bf16 v223, v207, v215, v223
    v_and_b32 v6, 7, v0
    v_lshlrev_b32 v6, 5, v6
    v_and_b32 v7, 16, v0
    v_add3_u32 v6, v6, v7, s68
    v_lshrrev_b32 v7, 5, v0
    v_lshl_add_u32 v6, v7, 3, v6
    v_add_f32_dpp v216, v216, v216 row_ror:8 row_mask:0xf bank_mask:0xf
    v_add_f32_dpp v217, v217, v217 row_ror:8 row_mask:0xf bank_mask:0xf
    v_add_f32_dpp v218, v218, v218 row_ror:8 row_mask:0xf bank_mask:0xf
    v_add_f32_dpp v219, v219, v219 row_ror:8 row_mask:0xf bank_mask:0xf
    v_add_f32_dpp v220, v220, v220 row_ror:8 row_mask:0xf bank_mask:0xf
    v_add_f32_dpp v221, v221, v221 row_ror:8 row_mask:0xf bank_mask:0xf
    v_add_f32_dpp v222, v222, v222 row_ror:8 row_mask:0xf bank_mask:0xf
    v_add_f32_dpp v223, v223, v223 row_ror:8 row_mask:0xf bank_mask:0xf
    v_permlane16_swap_b32 v216, v220
    v_permlane16_swap_b32 v217, v221
    v_permlane16_swap_b32 v218, v222
    v_permlane16_swap_b32 v219, v223
    v_add_f32 v216, v216, v220
    v_add_f32 v217, v217, v221
    v_add_f32 v218, v218, v222
    v_add_f32 v219, v219, v223
    s_nop 0
    v_permlane32_swap_b32 v216, v218
    v_permlane32_swap_b32 v217, v219
    v_add_f32 v216, v216, v218
    v_add_f32 v217, v217, v219
    ds_write_b64 v6, v[216:217] offset:16128
    s_waitcnt lgkmcnt(0)
    s_barrier
    s_cmp_lg_u32 s64, 0
    s_cbranch_scc1 L_nopub2
    v_lshlrev_b32 v7, 2, v0
    ds_read_b32 v216, v7 offset:16128
    ds_read_b32 v217, v7 offset:32512
    ds_read_b32 v218, v7 offset:48896
    ds_read_b32 v219, v7 offset:65280
    s_and_b32 s76, s61, 3
    s_lshl_b32 s76, s76, 2
    s_lshr_b32 s77, s61, 2
    s_add_u32 s76, s76, s77
    s_lshl_b32 s76, s76, 3
    s_add_u32 s76, s76, s60
    s_lshl_b32 s76, s76, 8
    s_add_u32 s76, s76, 0x13000
    v_lshlrev_b32 v9, 3, v0
    v_lshrrev_b32 v9, v9, s65
    s_movk_i32 s77, 0xff
    s_waitcnt lgkmcnt(0)
    v_add_f32 v216, v216, v217
    v_add_f32 v218, v218, v219
    v_add_f32 v216, v216, v218
    v_bfi_b32 v216, s77, v9, v216
    buffer_store_dword v216, v7, s[52:55], s76 offen sc1
L_nopub2:
    buffer_load_dwordx4 v[100:103], v1, s[52:55], s3 offen sc1
    s_sleep 2
    buffer_load_dwordx4 v[104:107], v1, s[52:55], s3 offen sc1
poll_kv_21:
    s_waitcnt vmcnt(2)
    v_cmp_ne_u32 vcc, s65, v99
    s_cbranch_vccz got_kv_23
    buffer_load_dwordx4 v[96:99], v1, s[52:55], s3 offen sc1
    s_waitcnt vmcnt(2)
    v_cmp_ne_u32 vcc, s65, v103
    s_cbranch_vccz got_kv_24
    buffer_load_dwordx4 v[100:103], v1, s[52:55], s3 offen sc1
    s_waitcnt vmcnt(2)
    v_cmp_ne_u32 vcc, s65, v107
    s_cbranch_vccz got_kv_25
    buffer_load_dwordx4 v[104:107], v1, s[52:55], s3 offen sc1
    s_sub_u32 s67, s67, 1
    s_cbranch_scc0 poll_kv_21
    s_endpgm
got_kv_23:
    v_mov_b32 v160, v96
    v_mov_b32 v161, v97
    v_cvt_pk_bf16_f32 v162, v98, v98
    s_branch done_kv_22
got_kv_24:
    v_mov_b32 v160, v100
    v_mov_b32 v161, v101
    v_cvt_pk_bf16_f32 v162, v102, v102
    s_branch done_kv_22
got_kv_25:
    v_mov_b32 v160, v104
    v_mov_b32 v161, v105
    v_cvt_pk_bf16_f32 v162, v106, v106
done_kv_22:
    ds_read_b64_tr_b16 a[48:49], v2 offset:0
    ds_read_b64_tr_b16 a[52:53], v3 offset:0
    ds_read_b64_tr_b16 a[50:51], v2 offset:1024
    ds_read_b64_tr_b16 a[54:55], v3 offset:1024
    ds_read_b64_tr_b16 a[56:57], v2 offset:2048
    ds_read_b64_tr_b16 a[60:61], v3 offset:2048
    ds_read_b64_tr_b16 a[58:59], v2 offset:3072
    ds_read_b64_tr_b16 a[62:63], v3 offset:3072
    v_add_u32 v6, s68, v14
    v_add_u32 v6, 0x3000, v6
    ds_read_b64 v[80:81], v6
    v_xor_b32 v7, 16, v6
    ds_read_b64 v[82:83], v7
    v_xor_b32 v7, 32, v6
    ds_read_b64 v[84:85], v7
    v_xor_b32 v7, 48, v6
    ds_read_b64 v[86:87], v7
    v_lshl_add_u32 v8, v0, 3, s68
    s_add_u32 m0, s91, 0x1f000
    s_add_u32 s79, s90, 0xd7000
    buffer_load_dwordx4 v236, s[40:43], s79 offen lds
    v_bfe_u32 v6, v0, 2, 1
    v_lshlrev_b32 v6, 4, v6
    v_bfe_u32 v7, v0, 3, 1
    v_lshl_add_u32 v6, v7, 3, v6
    v_and_b32 v7, 3, v0
    v_lshl_add_u32 v6, v7, 1, v6
    s_lshl_b32 s75, s64, 5
    s_add_u32 s75, s75, 0xfe00
    v_add_u32 v6, s75, v6
    ds_write_b64 v8, v[160:161] offset:15360
    ds_write_b16 v6, v162
    v_lshlrev_b32 v8, 3, v0
    v_add_u32 v8, 0x3c00, v8
    v_lshrrev_b32 v6, 5, v0
    v_lshlrev_b32 v6, 4, v6
    v_add_u32 v6, 0xfe00, v6
    v_bfe_u32 v7, v0, 4, 1
    v_cmp_eq_u32 vcc, 0, v7
    s_waitcnt lgkmcnt(0)
    s_barrier
    ds_read_b64 v[176:177], v8 offset:0
    ds_read_b64 v[178:179], v8 offset:16384
    ds_read_b64 v[180:181], v8 offset:32768
    ds_read_b64 v[182:183], v8 offset:49152
    ds_read_b128 v[200:203], v6 offset:0
    ds_read_b128 v[204:207], v6 offset:32
    ds_read_b128 v[208:211], v6 offset:64
    ds_read_b128 v[212:215], v6 offset:96
    s_waitcnt lgkmcnt(4)
    v_cndmask_b32 v184, v176, 0, vcc
    v_cndmask_b32 v185, v177, 0, vcc
    v_cndmask_b32 v186, v178, 0, vcc
    v_cndmask_b32 v187, v179, 0, vcc
    v_cndmask_b32 v188, v180, 0, vcc
    v_cndmask_b32 v189, v181, 0, vcc
    v_cndmask_b32 v190, v182, 0, vcc
    v_cndmask_b32 v191, v183, 0, vcc
    v_cndmask_b32 v176, 0, v176, vcc
    s_add_u32 m0, s91, 0x1f400
    s_add_u32 s79, s90, 0xd7000
    buffer_load_dwordx4 v237, s[40:43], s79 offen lds
    v_cndmask_b32 v177, 0, v177, vcc
    v_cndmask_b32 v178, 0, v178, vcc
    v_cndmask_b32 v179, 0, v179, vcc
    v_cndmask_b32 v180, 0, v180, vcc
    v_cndmask_b32 v181, 0, v181, vcc
    v_cndmask_b32 v182, 0, v182, vcc
    v_cndmask_b32 v183, 0, v183, vcc
    v_mfma_f32_32x32x16_bf16 v[160:175], v[176:179], v[144:147], 0
    s_nop 0
    v_mfma_f32_32x32x16_bf16 v[160:175], v[180:183], v[148:151], v[160:175]
    v_mfma_f32_32x32x16_bf16 v[160:175], v[184:187], v[152:155], v[160:175]
    s_add_u32 m0, s91, 0x1f800
    s_add_u32 s79, s90, 0xd7000
    buffer_load_dwordx4 v239, s[40:43], s79 offen lds
    v_mfma_f32_32x32x16_bf16 v[160:175], v[188:191], v[156:159], v[160:175]
    s_waitcnt lgkmcnt(0)
    v_dot2_f32_bf16 v216, v144, v200, 0
    v_dot2_f32_bf16 v218, v152, v208, 0
    v_dot2_f32_bf16 v216, v145, v201, v216
    v_dot2_f32_bf16 v218, v153, v209, v218
    v_dot2_f32_bf16 v216, v146, v202, v216
    v_dot2_f32_bf16 v218, v154, v210, v218
    v_dot2_f32_bf16 v216, v147, v203, v216
    v_dot2_f32_bf16 v218, v155, v211, v218
    v_dot2_f32_bf16 v216, v148, v204, v216
    v_dot2_f32_bf16 v218, v156, v212, v218
    v_dot2_f32_bf16 v216, v149, v205, v216
    v_dot2_f32_bf16 v218, v157, v213, v218
    v_dot2_f32_bf16 v216, v150, v206, v216
    v_dot2_f32_bf16 v218, v158, v214, v218
    v_dot2_f32_bf16 v216, v151, v207, v216
    v_dot2_f32_bf16 v218, v159, v215, v218
    s_nop 2
    v_permlane32_swap_b32 v216, v218
    s_add_u32 m0, s91, 0x22000
    s_add_u32 s79, s90, 0x102000
    buffer_load_dwordx4 v236, s[40:43], s79 offen lds
    v_add_f32 v216, v216, v218
    v_add_f32 v216, 0x358637bd, v216
    v_rcp_f32 v216, v216
    s_nop 0
    v_mov_b32 v218, v216
    s_nop 1
    v_permlane32_swap_b32 v216, v218
    v_pk_mul_f32 v[160:161], v[160:161], v[216:217] op_sel_hi:[1,0]
    v_pk_mul_f32 v[162:163], v[162:163], v[216:217] op_sel_hi:[1,0]
    v_pk_mul_f32 v[164:165], v[164:165], v[216:217] op_sel_hi:[1,0]
    v_pk_mul_f32 v[166:167], v[166:167], v[216:217] op_sel_hi:[1,0]
    v_pk_mul_f32 v[168:169], v[168:169], v[218:219] op_sel_hi:[1,0]
    v_pk_mul_f32 v[170:171], v[170:171], v[218:219] op_sel_hi:[1,0]
    v_pk_mul_f32 v[172:173], v[172:173], v[218:219] op_sel_hi:[1,0]
    v_pk_mul_f32 v[174:175], v[174:175], v[218:219] op_sel_hi:[1,0]
    v_cvt_pk_bf16_f32 v220, v160, v161
    v_cvt_pk_bf16_f32 v221, v162, v163
    v_cvt_pk_bf16_f32 v222, v164, v165
    v_cvt_pk_bf16_f32 v223, v166, v167
    v_cvt_pk_bf16_f32 v224, v168, v169
    v_cvt_pk_bf16_f32 v225, v170, v171
    v_cvt_pk_bf16_f32 v226, v172, v173
    s_add_u32 m0, s91, 0x22400
    s_add_u32 s79, s90, 0x102000
    buffer_load_dwordx4 v237, s[40:43], s79 offen lds
    v_cvt_pk_bf16_f32 v227, v174, v175
    s_lshl_b32 s75, s64, 6
    s_add_u32 s75, s75, s63
    s_lshl_b32 s75, s75, 11
    s_add_u32 s75, s75, 0x8000
    buffer_store_dwordx4 v[220:223], v1, s[56:59], s75 offen offset:0 sc1
    buffer_store_dwordx4 v[224:227], v1, s[56:59], s75 offen offset:1024 sc1
    s_lshl_b32 s78, s63, 2
    s_add_u32 s78, s78, s64
    s_lshl_b32 s78, s78, 2
    s_add_u32 s78, s78, 0x1f000
    v_mov_b32 v9, s65
    s_mov_b64 exec, 1
    s_waitcnt vmcnt(0)
    s_cmp_eq_u32 s66, 0
    s_cbranch_scc1 imp_26
    buffer_store_dword v9, off, s[56:59], s78 offset:256
    s_branch join_27
imp_26:
    buffer_store_dword v9, off, s[56:59], s78 offset:256 sc1
join_27:
    s_mov_b64 exec, -1
    buffer_load_dwordx4 v[16:19], v88, s[52:55], s97 offen offset:0 sc1
    buffer_load_dwordx4 v[20:23], v88, s[52:55], s97 offen offset:2048 sc1
    s_add_u32 s76, s97, 4096
    buffer_load_dwordx4 v[24:27], v88, s[52:55], s76 offen offset:0 sc1
    buffer_load_dwordx4 v[28:31], v88, s[52:55], s76 offen offset:2048 sc1
    buffer_load_dword v32, v89, s[52:55], s89 offen offset:0 sc1
    buffer_load_dword v33, v89, s[52:55], s89 offen offset:2048 sc1
    s_add_u32 s76, s89, 4096
    buffer_load_dword v34, v89, s[52:55], s76 offen offset:0 sc1
    buffer_load_dword v35, v89, s[52:55], s76 offen offset:2048 sc1
    s_waitcnt lgkmcnt(0)
    s_barrier
    v_bfe_u32 v6, v0, 1, 2
    v_and_b32 v9, 1, v0
    v_lshl_add_u32 v6, v6, 2, v9
    s_lshl_b32 s75, s64, 4
    s_and_b32 s76, s6, 2
    s_add_u32 s75, s75, s76
    v_add_lshl_u32 v6, v6, s75, 2
    s_lshl_b32 s73, s6, 4
    s_add_u32 s73, s73, s64
    s_lshl_b32 s73, s73, 13
    s_xor_b32 s74, s73, 0x20000
    s_mov_b32 s78, 0x1f100
    buffer_load_dword v160, v6, s[56:59], s78 offen sc1
    s_sleep 2
    buffer_load_dword v161, v6, s[56:59], s78 offen sc1
    s_sleep 2
    buffer_load_dword v162, v6, s[56:59], s78 offen sc1
poll_o_28:
    s_waitcnt vmcnt(2)
    v_cmp_ne_u32 vcc, s65, v160
    s_cbranch_vccz done_o_29
    buffer_load_dword v160, v6, s[56:59], s78 offen sc1
    s_waitcnt vmcnt(2)
    v_cmp_ne_u32 vcc, s65, v161
    s_cbranch_vccz done_o_29
    buffer_load_dword v161, v6, s[56:59], s78 offen sc1
    s_waitcnt vmcnt(2)
    v_cmp_ne_u32 vcc, s65, v162
    s_cbranch_vccz done_o_29
    buffer_load_dword v162, v6, s[56:59], s78 offen sc1
    s_sub_u32 s67, s67, 1
    s_cbranch_scc0 poll_o_28
    s_endpgm
done_o_29:
    s_add_u32 s77, s74, 0x8000
    buffer_load_dwordx4 v[96:99], v1, s[56:59], s77 offen offset:0 sc1
    buffer_load_dwordx4 v[100:103], v1, s[56:59], s77 offen offset:1024 sc1
    buffer_load_dwordx4 v[104:107], v1, s[56:59], s77 offen offset:2048 sc1
    buffer_load_dwordx4 v[108:111], v1, s[56:59], s77 offen offset:3072 sc1
    s_add_u32 s77, s74, 0x9000
    buffer_load_dwordx4 v[112:115], v1, s[56:59], s77 offen offset:0 sc1
    buffer_load_dwordx4 v[116:119], v1, s[56:59], s77 offen offset:1024 sc1
    buffer_load_dwordx4 v[120:123], v1, s[56:59], s77 offen offset:2048 sc1
    buffer_load_dwordx4 v[124:127], v1, s[56:59], s77 offen offset:3072 sc1
    s_add_u32 s77, s73, 0x8000
    buffer_load_dwordx4 v[128:131], v1, s[56:59], s77 offen offset:0 sc1
    buffer_load_dwordx4 v[132:135], v1, s[56:59], s77 offen offset:1024 sc1
    buffer_load_dwordx4 v[136:139], v1, s[56:59], s77 offen offset:2048 sc1
    buffer_load_dwordx4 v[140:143], v1, s[56:59], s77 offen offset:3072 sc1
    s_add_u32 s77, s73, 0x9000
    buffer_load_dwordx4 v[144:147], v1, s[56:59], s77 offen offset:0 sc1
    buffer_load_dwordx4 v[148:151], v1, s[56:59], s77 offen offset:1024 sc1
    buffer_load_dwordx4 v[152:155], v1, s[56:59], s77 offen offset:2048 sc1
    buffer_load_dwordx4 v[156:159], v1, s[56:59], s77 offen offset:3072 sc1
    v_add_u32 v12, s68, v1
    s_waitcnt vmcnt(15)
    v_mfma_f32_32x32x16_bf16 v[176:191], a[0:3], v[96:99], 0
    v_mfma_f32_32x32x16_bf16 v[208:223], a[4:7], v[96:99], 0
    s_bfe_u32 s92, s65, 0x80000
    s_bfe_u32 s93, s65, 0x80008
    s_bfe_u32 s94, s65, 0x80010
    s_bfe_u32 s95, s65, 0x80018
    s_branch chk_par_32
poll_par_30:
    s_nop 4
    buffer_load_dwordx4 v[16:19], v88, s[52:55], s97 offen offset:0 sc1
    buffer_load_dwordx4 v[20:23], v88, s[52:55], s97 offen offset:2048 sc1
    s_add_u32 s76, s97, 4096
    buffer_load_dwordx4 v[24:27], v88, s[52:55], s76 offen offset:0 sc1
    buffer_load_dwordx4 v[28:31], v88, s[52:55], s76 offen offset:2048 sc1
    buffer_load_dword v32, v89, s[52:55], s89 offen offset:0 sc1
    buffer_load_dword v33, v89, s[52:55], s89 offen offset:2048 sc1
    s_add_u32 s76, s89, 4096
    buffer_load_dword v34, v89, s[52:55], s76 offen offset:0 sc1
    buffer_load_dword v35, v89, s[52:55], s76 offen offset:2048 sc1
    s_waitcnt vmcnt(0)
chk_par_32:
    v_xor_b32 v16, s92, v16
    v_xor_b32 v17, s93, v17
    v_xor_b32 v18, s94, v18
    v_xor_b32 v19, s95, v19
    v_xor_b32 v20, s92, v20
    v_xor_b32 v21, s93, v21
    v_xor_b32 v22, s94, v22
    v_xor_b32 v23, s95, v23
    v_xor_b32 v24, s92, v24
    v_xor_b32 v25, s93, v25
    v_xor_b32 v26, s94, v26
    v_xor_b32 v27, s95, v27
    v_xor_b32 v28, s92, v28
    v_xor_b32 v29, s93, v29
    v_xor_b32 v30, s94, v30
    v_xor_b32 v31, s95, v31
    v_xor_b32 v32, v90, v32
    v_xor_b32 v33, v90, v33
    v_xor_b32 v34, v90, v34
    v_xor_b32 v35, v90, v35
    v_or_b32 v8, v16, v17
    v_or3_b32 v8, v8, v18, v19
    v_or3_b32 v8, v8, v20, v21
    v_or3_b32 v8, v8, v22, v23
    v_or3_b32 v8, v8, v24, v25
    v_or3_b32 v8, v8, v26, v27
    v_or3_b32 v8, v8, v28, v29
    v_or3_b32 v8, v8, v30, v31
    v_or3_b32 v8, v8, v32, v33
    v_or3_b32 v8, v8, v34, v35
    v_and_b32 v8, 0xff, v8
    v_cmp_ne_u32 vcc, 0, v8
    s_cbranch_vccz done_par_31
    s_sub_u32 s67, s67, 1
    s_cbranch_scc0 poll_par_30
    s_endpgm
done_par_31:
    v_pk_add_f32 v[16:17], v[16:17], v[20:21]
    v_pk_add_f32 v[24:25], v[24:25], v[28:29]
    v_pk_add_f32 v[18:19], v[18:19], v[22:23]
    v_pk_add_f32 v[26:27], v[26:27], v[30:31]
    v_add_f32 v32, v32, v33
    v_add_f32 v34, v34, v35
    v_pk_add_f32 v[16:17], v[16:17], v[24:25]
    v_pk_add_f32 v[18:19], v[18:19], v[26:27]
    v_add_f32 v32, v32, v34
    v_cmp_gt_u32 vcc, 32, v0
    s_cmp_eq_u32 s64, 1
    s_cselect_b32 s76, 1.0, 0
    v_cndmask_b32 v8, 0, 1.0, vcc
    v_cvt_pk_bf16_f32 v16, 0, v16
    v_cvt_pk_bf16_f32 v17, 0, v17
    v_cvt_pk_bf16_f32 v18, 0, v18
    v_cvt_pk_bf16_f32 v19, 0, v19
    v_cvt_pk_bf16_f32 v32, 0, v32
    v_add_f32 v16, v8, v16
    v_add_f32 v17, v8, v17
    v_add_f32 v18, v8, v18
    v_add_f32 v19, v8, v19
    v_add_f32 v32, s76, v32
    v_cvt_pk_bf16_f32 v16, v16, v17
    v_cvt_pk_bf16_f32 v17, v18, v19
    v_cvt_pk_bf16_f32 v32, 0, v32
    v_lshrrev_b32 v6, 2, v0
    v_lshlrev_b32 v6, 5, v6
    v_and_b32 v7, 1, v0
    v_lshl_add_u32 v6, v7, 4, v6
    v_and_b32 v7, 2, v0
    v_lshlrev_b32 v7, 2, v7
    v_add3_u32 v6, v6, v7, s68
    v_add_u32 v7, s68, v89
    ds_write_b64 v6, v[16:17] offset:15872
    ds_write_b32 v7, v32 offset:15360
    s_waitcnt vmcnt(14)
    v_mfma_f32_32x32x16_bf16 v[176:191], a[8:11], v[100:103], v[176:191]
    v_mfma_f32_32x32x16_bf16 v[208:223], a[12:15], v[100:103], v[208:223]
    s_waitcnt vmcnt(13)
    v_mfma_f32_32x32x16_bf16 v[176:191], a[16:19], v[104:107], v[176:191]
    v_mul_u32_u24 v9, 128, v0
    s_sub_u32 s78, s88, 0
    v_add_lshl_u32 v9, v9, s78, 10
    s_movk_i32 s79, 384
    s_mov_b64 exec, 0x7ff
    buffer_load_dword v15, v9, s[44:47], s79 offen
    s_mov_b64 exec, -1
    v_mfma_f32_32x32x16_bf16 v[208:223], a[20:23], v[104:107], v[208:223]
    s_waitcnt vmcnt(13)
    v_mfma_f32_32x32x16_bf16 v[176:191], a[24:27], v[108:111], v[176:191]
    v_mfma_f32_32x32x16_bf16 v[208:223], a[28:31], v[108:111], v[208:223]
    s_waitcnt vmcnt(12)
    v_mfma_f32_32x32x16_bf16 v[176:191], a[32:35], v[112:115], v[176:191]
    v_mfma_f32_32x32x16_bf16 v[208:223], a[36:39], v[112:115], v[208:223]
    s_and_b32 s78, s88, 3
    s_mul_i32 s78, s78, 2816
    s_lshr_b32 s79, s88, 2
    s_mul_i32 s79, s79, 22
    s_add_u32 s78, s78, s79
    s_add_u32 s78, s78, 2112
    v_add_lshl_u32 v9, v0, s78, 7
    s_mov_b64 exec, 0x3fffff
    buffer_load_dword v15, v9, s[44:47], 0 offen
    s_mov_b64 exec, -1
    s_waitcnt vmcnt(12)
    v_mfma_f32_32x32x16_bf16 v[176:191], a[40:43], v[116:119], v[176:191]
    v_mfma_f32_32x32x16_bf16 v[208:223], a[44:47], v[116:119], v[208:223]
    s_waitcnt vmcnt(11)
    v_mfma_f32_32x32x16_bf16 v[176:191], a[48:51], v[120:123], v[176:191]
    v_mfma_f32_32x32x16_bf16 v[208:223], a[52:55], v[120:123], v[208:223]
    s_add_u32 m0, s91, 0x22800
    s_add_u32 s79, s90, 0x102000
    buffer_load_dwordx4 v239, s[40:43], s79 offen lds
    s_waitcnt vmcnt(11)
    v_mfma_f32_32x32x16_bf16 v[176:191], a[56:59], v[124:127], v[176:191]
    v_mfma_f32_32x32x16_bf16 v[208:223], a[60:63], v[124:127], v[208:223]
    s_waitcnt vmcnt(10)
    v_mfma_f32_32x32x16_bf16 v[192:207], a[4:7], v[128:131], 0
    s_waitcnt vmcnt(9)
    v_mfma_f32_32x32x16_bf16 v[192:207], a[12:15], v[132:135], v[192:207]
    s_add_u32 m0, s91, 0x25000
    s_add_u32 s79, s90, 0x12d000
    buffer_load_dwordx4 v236, s[40:43], s79 offen lds
    s_nop 3
    ds_write_b128 v12, v[176:179] offset:0
    s_waitcnt vmcnt(9)
    v_mfma_f32_32x32x16_bf16 v[192:207], a[20:23], v[136:139], v[192:207]
    ds_write_b128 v12, v[180:183] offset:1024
    s_waitcnt vmcnt(8)
    v_mfma_f32_32x32x16_bf16 v[192:207], a[28:31], v[140:143], v[192:207]
    ds_write_b128 v12, v[184:187] offset:2048
    s_waitcnt vmcnt(7)
    v_mfma_f32_32x32x16_bf16 v[192:207], a[36:39], v[144:147], v[192:207]
    ds_write_b128 v12, v[188:191] offset:3072
    s_waitcnt vmcnt(6)
    v_mfma_f32_32x32x16_bf16 v[192:207], a[44:47], v[148:151], v[192:207]
    s_add_u32 m0, s91, 0x25400
    s_add_u32 s79, s90, 0x12d000
    buffer_load_dwordx4 v237, s[40:43], s79 offen lds
    ds_write_b128 v12, v[208:211] offset:8192
    s_waitcnt vmcnt(6)
    v_mfma_f32_32x32x16_bf16 v[192:207], a[52:55], v[152:155], v[192:207]
    ds_write_b128 v12, v[212:215] offset:9216
    s_waitcnt vmcnt(5)
    v_mfma_f32_32x32x16_bf16 v[192:207], a[60:63], v[156:159], v[192:207]
    ds_write_b128 v12, v[216:219] offset:10240
    v_mfma_f32_32x32x16_bf16 v[160:175], a[0:3], v[128:131], 0
    ds_write_b128 v12, v[220:223] offset:11264
    v_mfma_f32_32x32x16_bf16 v[160:175], a[8:11], v[132:135], v[160:175]
    s_add_u32 m0, s91, 0x25800
    s_add_u32 s79, s90, 0x12d000
    buffer_load_dwordx4 v239, s[40:43], s79 offen lds
    v_mfma_f32_32x32x16_bf16 v[160:175], a[16:19], v[136:139], v[160:175]
    s_nop 3
    ds_write_b128 v12, v[192:195] offset:4096
    v_mfma_f32_32x32x16_bf16 v[160:175], a[24:27], v[140:143], v[160:175]
    ds_write_b128 v12, v[196:199] offset:5120
    v_mfma_f32_32x32x16_bf16 v[160:175], a[32:35], v[144:147], v[160:175]
    ds_write_b128 v12, v[200:203] offset:6144
    v_mfma_f32_32x32x16_bf16 v[160:175], a[40:43], v[148:151], v[160:175]
    s_add_u32 m0, s68, 0x3000
    s_add_u32 s79, s13, 0x1e000
    buffer_load_dwordx4 v4, s[44:47], s79 offen lds
    ds_write_b128 v12, v[204:207] offset:7168
    v_mfma_f32_32x32x16_bf16 v[160:175], a[48:51], v[152:155], v[160:175]
    v_mfma_f32_32x32x16_bf16 v[160:175], a[56:59], v[156:159], v[160:175]
    v_xor_b32 v6, 0x4000, v12
    v_xor_b32 v7, 0x8000, v12
    v_xor_b32 v8, 0xc000, v12
    v_lshrrev_b32 v9, 5, v0
    s_lshr_b32 s75, s64, 1
    s_lshl_b32 s75, s75, 7
    s_add_u32 s75, s75, 0x3c00
    v_lshl_add_u32 v9, v9, 4, s75
    v_lshlrev_b32 v96, 16, v80
    v_and_b32 v97, s71, v80
    v_lshlrev_b32 v98, 16, v81
    v_and_b32 v99, s71, v81
    v_lshlrev_b32 v100, 16, v82
    v_and_b32 v101, s71, v82
    v_lshlrev_b32 v102, 16, v83
    v_and_b32 v103, s71, v83
    v_lshlrev_b32 v104, 16, v84
    v_and_b32 v105, s71, v84
    v_lshlrev_b32 v106, 16, v85
    v_and_b32 v107, s71, v85
    v_lshlrev_b32 v108, 16, v86
    v_and_b32 v109, s71, v86
    v_lshlrev_b32 v110, 16, v87
    v_and_b32 v111, s71, v87
    s_waitcnt lgkmcnt(0)
    s_barrier
    s_add_u32 m0, s68, 0x3400
    s_add_u32 s79, s13, 0x20000
    buffer_load_dwordx4 v4, s[44:47], s79 offen lds
    s_add_u32 m0, s68, 0x3800
    s_add_u32 s79, s13, 0x22000
    buffer_load_dwordx4 v4, s[44:47], s79 offen lds
    ds_read_b128 v[176:179], v6 offset:0
    ds_read_b128 v[180:183], v6 offset:1024
    ds_read_b128 v[184:187], v6 offset:2048
    ds_read_b128 v[188:191], v6 offset:3072
    ds_read_b128 v[192:195], v7 offset:4096
    ds_read_b128 v[196:199], v7 offset:5120
    ds_read_b128 v[200:203], v7 offset:6144
    ds_read_b128 v[204:207], v7 offset:7168
    ds_read_b128 v[208:211], v8 offset:8192
    ds_read_b128 v[212:215], v8 offset:9216
    ds_read_b128 v[216:219], v8 offset:10240
    ds_read_b128 v[220:223], v8 offset:11264
    s_waitcnt lgkmcnt(8)
    ds_read_b128 v[16:19], v9 offset:0
    ds_read_b128 v[20:23], v9 offset:32
    ds_read_b128 v[24:27], v9 offset:64
    ds_read_b128 v[28:31], v9 offset:96
    v_pk_add_f32 v[160:161], v[160:161], v[176:177]
    v_pk_add_f32 v[162:163], v[162:163], v[178:179]
    v_pk_add_f32 v[164:165], v[164:165], v[180:181]
    v_pk_add_f32 v[166:167], v[166:167], v[182:183]
    v_pk_add_f32 v[168:169], v[168:169], v[184:185]
    v_pk_add_f32 v[170:171], v[170:171], v[186:187]
    v_pk_add_f32 v[172:173], v[172:173], v[188:189]
    v_pk_add_f32 v[174:175], v[174:175], v[190:191]
    s_waitcnt lgkmcnt(8)
    ds_read_b128 v[32:35], v9 offset:16384
    ds_read_b128 v[36:39], v9 offset:16416
    ds_read_b128 v[40:43], v9 offset:16448
    ds_read_b128 v[44:47], v9 offset:16480
    v_pk_add_f32 v[160:161], v[160:161], v[192:193]
    v_pk_add_f32 v[162:163], v[162:163], v[194:195]
    v_pk_add_f32 v[164:165], v[164:165], v[196:197]
    v_pk_add_f32 v[166:167], v[166:167], v[198:199]
    v_pk_add_f32 v[168:169], v[168:169], v[200:201]
    v_pk_add_f32 v[170:171], v[170:171], v[202:203]
    v_pk_add_f32 v[172:173], v[172:173], v[204:205]
    v_pk_add_f32 v[174:175], v[174:175], v[206:207]
    s_waitcnt lgkmcnt(8)
    ds_read_b128 v[240:243], v9 offset:32768
    ds_read_b128 v[244:247], v9 offset:32800
    ds_read_b128 v[248:251], v9 offset:32832
    ds_read_b128 v[252:255], v9 offset:32864
    v_pk_add_f32 v[160:161], v[160:161], v[208:209]
    v_pk_add_f32 v[162:163], v[162:163], v[210:211]
    v_pk_add_f32 v[164:165], v[164:165], v[212:213]
    v_pk_add_f32 v[166:167], v[166:167], v[214:215]
    v_pk_add_f32 v[168:169], v[168:169], v[216:217]
    v_pk_add_f32 v[170:171], v[170:171], v[218:219]
    v_pk_add_f32 v[172:173], v[172:173], v[220:221]
    v_pk_add_f32 v[174:175], v[174:175], v[222:223]
    s_waitcnt lgkmcnt(8)
    v_pk_fma_f32 v[160:161], v[160:161], v[16:17], v[96:97]
    v_pk_fma_f32 v[162:163], v[162:163], v[18:19], v[98:99]
    v_pk_fma_f32 v[164:165], v[164:165], v[20:21], v[100:101]
    v_pk_fma_f32 v[166:167], v[166:167], v[22:23], v[102:103]
    v_pk_fma_f32 v[168:169], v[168:169], v[24:25], v[104:105]
    v_pk_fma_f32 v[170:171], v[170:171], v[26:27], v[106:107]
    v_pk_fma_f32 v[172:173], v[172:173], v[28:29], v[108:109]
    v_pk_fma_f32 v[174:175], v[174:175], v[30:31], v[110:111]
    v_cvt_pk_bf16_f32 v112, v160, v161
    v_cvt_pk_bf16_f32 v113, v162, v163
    v_cvt_pk_bf16_f32 v114, v164, v165
    v_cvt_pk_bf16_f32 v115, v166, v167
    v_cvt_pk_bf16_f32 v116, v168, v169
    v_cvt_pk_bf16_f32 v117, v170, v171
    v_cvt_pk_bf16_f32 v118, v172, v173
    v_cvt_pk_bf16_f32 v119, v174, v175
    v_lshlrev_b32 v160, 16, v112
    v_and_b32 v161, s71, v112
    v_lshlrev_b32 v162, 16, v113
    v_and_b32 v163, s71, v113
    v_lshlrev_b32 v164, 16, v114
    v_and_b32 v165, s71, v114
    v_lshlrev_b32 v166, 16, v115
    v_and_b32 v167, s71, v115
    v_lshlrev_b32 v168, 16, v116
    v_and_b32 v169, s71, v116
    v_lshlrev_b32 v170, 16, v117
    v_and_b32 v171, s71, v117
    v_lshlrev_b32 v172, 16, v118
    v_and_b32 v173, s71, v118
    v_lshlrev_b32 v174, 16, v119
    v_and_b32 v175, s71, v119
    s_waitcnt lgkmcnt(4)
    v_pk_mul_f32 v[96:97], v[160:161], v[32:33]
    v_pk_mul_f32 v[98:99], v[162:163], v[34:35]
    v_pk_mul_f32 v[100:101], v[164:165], v[36:37]
    v_pk_mul_f32 v[102:103], v[166:167], v[38:39]
    v_pk_mul_f32 v[104:105], v[168:169], v[40:41]
    v_pk_mul_f32 v[106:107], v[170:171], v[42:43]
    v_pk_mul_f32 v[108:109], v[172:173], v[44:45]
    v_pk_mul_f32 v[110:111], v[174:175], v[46:47]
    v_cvt_pk_bf16_f32 v120, v96, v97
    v_cvt_pk_bf16_f32 v121, v98, v99
    v_cvt_pk_bf16_f32 v122, v100, v101
    v_cvt_pk_bf16_f32 v123, v102, v103
    v_cvt_pk_bf16_f32 v124, v104, v105
    v_cvt_pk_bf16_f32 v125, v106, v107
    v_cvt_pk_bf16_f32 v126, v108, v109
    v_cvt_pk_bf16_f32 v127, v110, v111
    v_pk_add_f32 v[128:129], v[160:161], v[162:163]
    v_pk_mul_f32 v[130:131], v[160:161], v[160:161]
    v_pk_fma_f32 v[130:131], v[162:163], v[162:163], v[130:131]
    v_pk_add_f32 v[128:129], v[128:129], v[164:165]
    v_pk_fma_f32 v[130:131], v[164:165], v[164:165], v[130:131]
    v_pk_add_f32 v[128:129], v[128:129], v[166:167]
    v_pk_fma_f32 v[130:131], v[166:167], v[166:167], v[130:131]
    v_pk_add_f32 v[128:129], v[128:129], v[168:169]
    v_pk_fma_f32 v[130:131], v[168:169], v[168:169], v[130:131]
    v_pk_add_f32 v[128:129], v[128:129], v[170:171]
    v_pk_fma_f32 v[130:131], v[170:171], v[170:171], v[130:131]
    v_pk_add_f32 v[128:129], v[128:129], v[172:173]
    v_pk_fma_f32 v[130:131], v[172:173], v[172:173], v[130:131]
    v_pk_add_f32 v[128:129], v[128:129], v[174:175]
    v_pk_fma_f32 v[130:131], v[174:175], v[174:175], v[130:131]
    v_add_f32 v128, v128, v129
    v_add_f32 v130, v130, v131
    s_nop 1
    v_permlane32_swap_b32 v128, v130
    v_add_f32 v128, v128, v130
    v_and_b32 v6, 31, v0
    v_lshlrev_b32 v6, 4, v6
    v_lshrrev_b32 v7, 5, v0
    v_lshl_add_u32 v6, v7, 2, v6
    s_lshl_b32 s75, s6, 17
    s_lshr_b32 s76, s4, 1
    s_lshl_b32 s76, s76, 9
    s_add_u32 s75, s75, s76
    s_and_b32 s76, s4, 1
    s_lshl_b32 s76, s76, 3
    s_add_u32 s75, s75, s76
    s_add_u32 s75, s75, 0x1e000
    s_lshl_b32 s76, s6, 6
    s_add_u32 s76, s76, s4
    s_lshl_b32 s76, s76, 11
    buffer_store_dwordx4 v[120:123], v1, s[56:59], s76 offen offset:0 sc1
    buffer_store_dwordx4 v[124:127], v1, s[56:59], s76 offen offset:1024 sc1
    buffer_store_dword v128, v6, s[56:59], s75 offen offset:0 sc1
    s_waitcnt vmcnt(3)
    ds_read_b64_tr_b16 a[122:123], v2 offset:12288
    ds_read_b64_tr_b16 a[126:127], v3 offset:12288
    ds_read_b64_tr_b16 a[128:129], v2 offset:13312
    ds_read_b64_tr_b16 a[132:133], v3 offset:13312
    ds_read_b64_tr_b16 a[130:131], v2 offset:14336
    ds_read_b64_tr_b16 a[134:135], v3 offset:14336
    v_lshrrev_b32 v6, 5, v0
    v_bfe_u32 v7, v0, 2, 2
    v_lshl_add_u32 v7, v6, 2, v7
    v_mul_u32_u24 v7, 192, v7
    s_mov_b32 s75, 0x10000
    v_add3_u32 v11, v7, v10, s75
    v_bfe_u32 v7, v0, 2, 1
    v_lshlrev_b32 v7, 8, v7
    v_lshl_add_u32 v7, v6, 4, v7
    v_add_u32 v7, s68, v7
    s_mul_i32 s75, s64, 24576
    v_add_u32 v8, s75, v11
    v_and_b32 v147, 15, v0
    v_lshlrev_b32 v147, 1, v147
    s_lshr_b32 s75, s64, 1
    s_lshl_b32 s75, s75, 5
    s_and_b32 s76, s64, 1
    s_add_u32 s75, s75, s76
    v_add_lshl_u32 v147, v147, s75, 2
    v_and_b32 v148, 2, v0
    v_lshlrev_b32 v148, 1, v148
    v_xor_b32 v147, v147, v148
    v_add_u32 v147, 0x1f200, v147
    s_waitcnt lgkmcnt(0)
    s_barrier
    s_add_u32 m0, s68, 0x0
    s_add_u32 s79, s13, 0x0
    buffer_load_dwordx4 v4, s[44:47], s79 offen lds
    s_add_u32 m0, s68, 0x400
    s_add_u32 s79, s13, 0x2000
    buffer_load_dwordx4 v4, s[44:47], s79 offen lds
    s_add_u32 m0, s68, 0x800
    s_add_u32 s79, s13, 0x4000
    buffer_load_dwordx4 v4, s[44:47], s79 offen lds
    s_add_u32 m0, s68, 0xc00
    s_add_u32 s79, s13, 0x6000
    buffer_load_dwordx4 v4, s[44:47], s79 offen lds
    ds_read_b128 v[64:67], v7 offset:15872
    ds_read_b64_tr_b16 v[68:69], v8 offset:0
    ds_read_b64_tr_b16 v[70:71], v8 offset:1536
    ds_read_b64_tr_b16 v[72:73], v8 offset:64
    ds_read_b64_tr_b16 v[74:75], v8 offset:1600
    ds_read_b64_tr_b16 v[76:77], v8 offset:128
    ds_read_b64_tr_b16 v[78:79], v8 offset:1664
    ds_read_b128 v[80:83], v7 offset:15904
    ds_read_b64_tr_b16 v[84:85], v8 offset:3072
    ds_read_b64_tr_b16 v[86:87], v8 offset:4608
    ds_read_b64_tr_b16 v[88:89], v8 offset:3136
    ds_read_b64_tr_b16 v[90:91], v8 offset:4672
    ds_read_b64_tr_b16 v[92:93], v8 offset:3200
    ds_read_b64_tr_b16 v[94:95], v8 offset:4736
    s_waitcnt lgkmcnt(11)
    v_mfma_f32_32x32x16_bf16 v[16:31], v[64:67], v[68:71], 0
    v_accvgpr_write_b32 a240, v160
    v_accvgpr_write_b32 a241, v161
    s_add_u32 m0, s68, 0x1000
    s_add_u32 s79, s13, 0x8000
    buffer_load_dwordx4 v4, s[44:47], s79 offen lds
    s_waitcnt lgkmcnt(9)
    v_mfma_f32_32x32x16_bf16 v[32:47], v[64:67], v[72:75], 0
    s_waitcnt lgkmcnt(7)
    v_mfma_f32_32x32x16_bf16 v[48:63], v[64:67], v[76:79], 0
    ds_read_b128 v[64:67], v7 offset:15936
    ds_read_b64_tr_b16 v[68:69], v8 offset:6144
    ds_read_b64_tr_b16 v[70:71], v8 offset:7680
    ds_read_b64_tr_b16 v[72:73], v8 offset:6208
    ds_read_b64_tr_b16 v[74:75], v8 offset:7744
    ds_read_b64_tr_b16 v[76:77], v8 offset:6272
    ds_read_b64_tr_b16 v[78:79], v8 offset:7808
    s_waitcnt lgkmcnt(11)
    v_mfma_f32_32x32x16_bf16 v[16:31], v[80:83], v[84:87], v[16:31]
    v_accvgpr_write_b32 a242, v162
    v_accvgpr_write_b32 a243, v163
    s_waitcnt lgkmcnt(9)
    v_mfma_f32_32x32x16_bf16 v[32:47], v[80:83], v[88:91], v[32:47]
    s_add_u32 m0, s68, 0x1400
    s_add_u32 s79, s13, 0xa000
    buffer_load_dwordx4 v4, s[44:47], s79 offen lds
    s_waitcnt lgkmcnt(7)
    v_mfma_f32_32x32x16_bf16 v[48:63], v[80:83], v[92:95], v[48:63]
    ds_read_b128 v[80:83], v7 offset:15968
    ds_read_b64_tr_b16 v[84:85], v8 offset:9216
    ds_read_b64_tr_b16 v[86:87], v8 offset:10752
    ds_read_b64_tr_b16 v[88:89], v8 offset:9280
    ds_read_b64_tr_b16 v[90:91], v8 offset:10816
    ds_read_b64_tr_b16 v[92:93], v8 offset:9344
    ds_read_b64_tr_b16 v[94:95], v8 offset:10880
    s_waitcnt lgkmcnt(11)
    v_mfma_f32_32x32x16_bf16 v[16:31], v[64:67], v[68:71], v[16:31]
    v_accvgpr_write_b32 a244, v164
    v_accvgpr_write_b32 a245, v165
    s_waitcnt lgkmcnt(9)
    v_mfma_f32_32x32x16_bf16 v[32:47], v[64:67], v[72:75], v[32:47]
    s_waitcnt lgkmcnt(7)
    v_mfma_f32_32x32x16_bf16 v[48:63], v[64:67], v[76:79], v[48:63]
    s_add_u32 m0, s68, 0x1800
    s_add_u32 s79, s13, 0xc000
    buffer_load_dwordx4 v4, s[44:47], s79 offen lds
    ds_read_b128 v[64:67], v7 offset:16000
    ds_read_b64_tr_b16 v[68:69], v8 offset:12288
    ds_read_b64_tr_b16 v[70:71], v8 offset:13824
    ds_read_b64_tr_b16 v[72:73], v8 offset:12352
    ds_read_b64_tr_b16 v[74:75], v8 offset:13888
    ds_read_b64_tr_b16 v[76:77], v8 offset:12416
    ds_read_b64_tr_b16 v[78:79], v8 offset:13952
    s_lshl_b32 s78, s63, 2
    s_add_u32 s78, s78, s64
    s_lshl_b32 s78, s78, 2
    s_add_u32 s78, s78, 0x1f000
    v_mov_b32 v9, s65
    s_mov_b64 exec, 1
    s_waitcnt vmcnt(7)
    s_cmp_eq_u32 s66, 0
    s_cbranch_scc1 imp_33
    buffer_store_dword v9, off, s[56:59], s78 offset:512
    s_branch join_34
imp_33:
    buffer_store_dword v9, off, s[56:59], s78 offset:512 sc1
join_34:
    s_mov_b64 exec, -1
    s_waitcnt lgkmcnt(11)
    v_mfma_f32_32x32x16_bf16 v[16:31], v[80:83], v[84:87], v[16:31]
    v_accvgpr_write_b32 a246, v166
    v_accvgpr_write_b32 a247, v167
    s_waitcnt lgkmcnt(9)
    v_mfma_f32_32x32x16_bf16 v[32:47], v[80:83], v[88:91], v[32:47]
    s_waitcnt lgkmcnt(7)
    v_mfma_f32_32x32x16_bf16 v[48:63], v[80:83], v[92:95], v[48:63]
    ds_read_b128 v[80:83], v7 offset:16032
    ds_read_b64_tr_b16 v[84:85], v8 offset:15360
    ds_read_b64_tr_b16 v[86:87], v8 offset:16896
    ds_read_b64_tr_b16 v[88:89], v8 offset:15424
    ds_read_b64_tr_b16 v[90:91], v8 offset:16960
    ds_read_b64_tr_b16 v[92:93], v8 offset:15488
    ds_read_b64_tr_b16 v[94:95], v8 offset:17024
    s_waitcnt lgkmcnt(11)
    v_mfma_f32_32x32x16_bf16 v[16:31], v[64:67], v[68:71], v[16:31]
    s_add_u32 m0, s68, 0x1c00
    s_add_u32 s79, s13, 0xe000
    buffer_load_dwordx4 v4, s[44:47], s79 offen lds
    v_accvgpr_write_b32 a248, v168
    v_accvgpr_write_b32 a249, v169
    s_waitcnt lgkmcnt(9)
    v_mfma_f32_32x32x16_bf16 v[32:47], v[64:67], v[72:75], v[32:47]
    s_waitcnt lgkmcnt(7)
    v_mfma_f32_32x32x16_bf16 v[48:63], v[64:67], v[76:79], v[48:63]
    ds_read_b128 v[64:67], v7 offset:16064
    ds_read_b64_tr_b16 v[68:69], v8 offset:18432
    ds_read_b64_tr_b16 v[70:71], v8 offset:19968
    ds_read_b64_tr_b16 v[72:73], v8 offset:18496
    ds_read_b64_tr_b16 v[74:75], v8 offset:20032
    ds_read_b64_tr_b16 v[76:77], v8 offset:18560
    ds_read_b64_tr_b16 v[78:79], v8 offset:20096
    s_waitcnt lgkmcnt(11)
    v_mfma_f32_32x32x16_bf16 v[16:31], v[80:83], v[84:87], v[16:31]
    v_accvgpr_write_b32 a250, v170
    v_accvgpr_write_b32 a251, v171
    s_waitcnt lgkmcnt(9)
    v_mfma_f32_32x32x16_bf16 v[32:47], v[80:83], v[88:91], v[32:47]
    s_add_u32 m0, s68, 0x2000
    s_add_u32 s79, s13, 0x10000
    buffer_load_dwordx4 v4, s[44:47], s79 offen lds
    s_waitcnt lgkmcnt(7)
    v_mfma_f32_32x32x16_bf16 v[48:63], v[80:83], v[92:95], v[48:63]
    ds_read_b128 v[80:83], v7 offset:16096
    ds_read_b64_tr_b16 v[84:85], v8 offset:21504
    ds_read_b64_tr_b16 v[86:87], v8 offset:23040
    ds_read_b64_tr_b16 v[88:89], v8 offset:21568
    ds_read_b64_tr_b16 v[90:91], v8 offset:23104
    ds_read_b64_tr_b16 v[92:93], v8 offset:21632
    ds_read_b64_tr_b16 v[94:95], v8 offset:23168
    s_waitcnt lgkmcnt(11)
    v_mfma_f32_32x32x16_bf16 v[16:31], v[64:67], v[68:71], v[16:31]
    v_accvgpr_write_b32 a252, v172
    v_accvgpr_write_b32 a253, v173
    s_waitcnt lgkmcnt(9)
    v_mfma_f32_32x32x16_bf16 v[32:47], v[64:67], v[72:75], v[32:47]
    s_waitcnt lgkmcnt(7)
    v_mfma_f32_32x32x16_bf16 v[48:63], v[64:67], v[76:79], v[48:63]
    s_add_u32 m0, s68, 0x2400
    s_add_u32 s79, s13, 0x12000
    buffer_load_dwordx4 v4, s[44:47], s79 offen lds
    buffer_load_dword v144, v147, s[56:59], 0 offen sc1
    s_waitcnt lgkmcnt(4)
    v_mfma_f32_32x32x16_bf16 v[16:31], v[80:83], v[84:87], v[16:31]
    v_accvgpr_write_b32 a254, v174
    v_accvgpr_write_b32 a255, v175
    s_waitcnt lgkmcnt(2)
    v_mfma_f32_32x32x16_bf16 v[32:47], v[80:83], v[88:91], v[32:47]
    s_waitcnt lgkmcnt(0)
    v_mfma_f32_32x32x16_bf16 v[48:63], v[80:83], v[92:95], v[48:63]
    buffer_load_dword v145, v147, s[56:59], 0 offen sc1
    v_lshl_add_u32 v7, v0, 2, s68
    s_nop 3
    ds_write_b32 v7, v16 offset:15360
    s_nop 2
    ds_write_b32 v7, v32 offset:15616
    s_nop 0
    ds_write_b32 v7, v48 offset:15872
    s_add_u32 m0, s68, 0x2800
    s_add_u32 s79, s13, 0x14000
    buffer_load_dwordx4 v4, s[44:47], s79 offen lds
    s_add_u32 m0, s68, 0x2c00
    s_add_u32 s79, s13, 0x16000
    buffer_load_dwordx4 v4, s[44:47], s79 offen lds
    s_add_u32 m0, s68, 0x3000
    s_add_u32 s79, s13, 0x18000
    buffer_load_dwordx4 v4, s[44:47], s79 offen lds
    s_add_u32 m0, s68, 0x3400
    s_add_u32 s79, s13, 0x1a000
    buffer_load_dwordx4 v4, s[44:47], s79 offen lds
    s_add_u32 m0, s68, 0x3800
    s_add_u32 s79, s13, 0x1c000
    buffer_load_dwordx4 v4, s[44:47], s79 offen lds
    buffer_load_dword v146, v147, s[56:59], 0 offen sc1
    s_waitcnt lgkmcnt(0)
    s_barrier
    v_add_u32 v12, 0xc000, v11
    ds_read_b64_tr_b16 a[0:1], v11 offset:0
    ds_read_b64_tr_b16 a[2:3], v11 offset:1536
    ds_read_b64_tr_b16 a[4:5], v11 offset:64
    ds_read_b64_tr_b16 a[6:7], v11 offset:1600
    ds_read_b64_tr_b16 a[8:9], v11 offset:3072
    ds_read_b64_tr_b16 a[10:11], v11 offset:4608
    ds_read_b64_tr_b16 a[12:13], v11 offset:3136
    ds_read_b64_tr_b16 a[14:15], v11 offset:4672
    ds_read_b64_tr_b16 a[16:17], v11 offset:6144
    ds_read_b64_tr_b16 a[18:19], v11 offset:7680
    v_and_b32 v7, 31, v0
    v_lshlrev_b32 v7, 4, v7
    v_lshrrev_b32 v8, 5, v0
    v_lshl_add_u32 v7, v8, 11, v7
    s_lshl_b32 s72, s64, 17
    s_add_u32 s75, s72, 0x1e000
    s_waitcnt vmcnt(7)
    v_cmp_ne_u32 vcc, s65, v144
    s_cbranch_vccz done_y_36
    buffer_load_dword v144, v147, s[56:59], 0 offen sc1
    s_waitcnt vmcnt(7)
    v_cmp_ne_u32 vcc, s65, v145
    s_cbranch_vccz done_y_36
    buffer_load_dword v145, v147, s[56:59], 0 offen sc1
    s_waitcnt vmcnt(2)
    v_cmp_ne_u32 vcc, s65, v146
    s_cbranch_vccz done_y_36
    buffer_load_dword v146, v147, s[56:59], 0 offen sc1
poll_y_35:
    s_waitcnt vmcnt(2)
    v_cmp_ne_u32 vcc, s65, v144
    s_cbranch_vccz done_y_36
    buffer_load_dword v144, v147, s[56:59], 0 offen sc1
    s_waitcnt vmcnt(2)
    v_cmp_ne_u32 vcc, s65, v145
    s_cbranch_vccz done_y_36
    buffer_load_dword v145, v147, s[56:59], 0 offen sc1
    s_waitcnt vmcnt(2)
    v_cmp_ne_u32 vcc, s65, v146
    s_cbranch_vccz done_y_36
    buffer_load_dword v146, v147, s[56:59], 0 offen sc1
    s_sub_u32 s67, s67, 1
    s_cbranch_scc0 poll_y_35
    s_endpgm
done_y_36:
    s_add_u32 s77, s72, 0x0
    buffer_load_dwordx4 v[16:19], v1, s[56:59], s77 offen offset:0 sc1
    buffer_load_dwordx4 v[20:23], v1, s[56:59], s77 offen offset:1024 sc1
    buffer_load_dwordx4 v[24:27], v1, s[56:59], s77 offen offset:2048 sc1
    buffer_load_dwordx4 v[28:31], v1, s[56:59], s77 offen offset:3072 sc1
    s_add_u32 s77, s72, 0x1000
    buffer_load_dwordx4 v[32:35], v1, s[56:59], s77 offen offset:0 sc1
    buffer_load_dwordx4 v[36:39], v1, s[56:59], s77 offen offset:1024 sc1
    buffer_load_dwordx4 v[40:43], v1, s[56:59], s77 offen offset:2048 sc1
    buffer_load_dwordx4 v[44:47], v1, s[56:59], s77 offen offset:3072 sc1
    s_waitcnt vmcnt(7)
    s_waitcnt lgkmcnt(8)
    v_mfma_f32_32x32x16_bf16 v[144:159], a[0:3], v[16:19], 0
    ds_read_b64_tr_b16 a[20:21], v11 offset:6208
    ds_read_b64_tr_b16 a[22:23], v11 offset:7744
    s_add_u32 s77, s72, 0x2000
    buffer_load_dwordx4 v[48:51], v1, s[56:59], s77 offen offset:0 sc1
    s_waitcnt lgkmcnt(8)
    v_mfma_f32_32x32x16_bf16 v[160:175], a[4:7], v[16:19], 0
    ds_read_b64_tr_b16 a[24:25], v11 offset:9216
    ds_read_b64_tr_b16 a[26:27], v11 offset:10752
    s_waitcnt vmcnt(7)
    s_waitcnt lgkmcnt(8)
    v_mfma_f32_32x32x16_bf16 v[144:159], a[8:11], v[20:23], v[144:159]
    ds_read_b64_tr_b16 a[28:29], v11 offset:9280
    ds_read_b64_tr_b16 a[30:31], v11 offset:10816
    buffer_load_dwordx4 v[52:55], v1, s[56:59], s77 offen offset:1024 sc1
    buffer_load_dwordx4 v[192:195], v7, s[56:59], s75 offen offset:0 sc1
    buffer_load_dwordx4 v[196:199], v7, s[56:59], s75 offen offset:512 sc1
    buffer_load_dwordx4 v[200:203], v7, s[56:59], s75 offen offset:1024 sc1
    buffer_load_dwordx4 v[204:207], v7, s[56:59], s75 offen offset:1536 sc1
    s_waitcnt lgkmcnt(8)
    v_mfma_f32_32x32x16_bf16 v[160:175], a[12:15], v[20:23], v[160:175]
    ds_read_b64_tr_b16 a[0:1], v11 offset:12288
    ds_read_b64_tr_b16 a[2:3], v11 offset:13824
    s_waitcnt vmcnt(11)
    s_waitcnt lgkmcnt(8)
    v_mfma_f32_32x32x16_bf16 v[144:159], a[16:19], v[24:27], v[144:159]
    ds_read_b64_tr_b16 a[4:5], v11 offset:12352
    ds_read_b64_tr_b16 a[6:7], v11 offset:13888
    buffer_load_dwordx4 v[56:59], v1, s[56:59], s77 offen offset:2048 sc1
    s_waitcnt lgkmcnt(8)
    v_mfma_f32_32x32x16_bf16 v[160:175], a[20:23], v[24:27], v[160:175]
    ds_read_b64_tr_b16 a[8:9], v11 offset:15360
    ds_read_b64_tr_b16 a[10:11], v11 offset:16896
    s_waitcnt vmcnt(11)
    s_waitcnt lgkmcnt(8)
    v_mfma_f32_32x32x16_bf16 v[144:159], a[24:27], v[28:31], v[144:159]
    ds_read_b64_tr_b16 a[12:13], v11 offset:15424
    ds_read_b64_tr_b16 a[14:15], v11 offset:16960
    buffer_load_dwordx4 v[60:63], v1, s[56:59], s77 offen offset:3072 sc1
    v_lshlrev_b32 v6, 2, v0
    ds_read_b32 v212, v6 offset:15360
    ds_read_b32 v213, v6 offset:31744
    s_waitcnt lgkmcnt(10)
    v_mfma_f32_32x32x16_bf16 v[160:175], a[28:31], v[28:31], v[160:175]
    ds_read_b64_tr_b16 a[16:17], v11 offset:18432
    ds_read_b64_tr_b16 a[18:19], v11 offset:19968
    ds_read_b32 v214, v6 offset:48128
    ds_read_b32 v215, v6 offset:64512
    s_waitcnt vmcnt(11)
    s_waitcnt lgkmcnt(12)
    v_mfma_f32_32x32x16_bf16 v[144:159], a[0:3], v[32:35], v[144:159]
    ds_read_b64_tr_b16 a[20:21], v11 offset:18496
    ds_read_b64_tr_b16 a[22:23], v11 offset:20032
    s_add_u32 s77, s72, 0x3000
    buffer_load_dwordx4 v[64:67], v1, s[56:59], s77 offen offset:0 sc1
    ds_read_b32 v216, v6 offset:15616
    ds_read_b32 v217, v6 offset:32000
    s_waitcnt lgkmcnt(14)
    v_mfma_f32_32x32x16_bf16 v[160:175], a[4:7], v[32:35], v[160:175]
    ds_read_b64_tr_b16 a[24:25], v11 offset:21504
    ds_read_b64_tr_b16 a[26:27], v11 offset:23040
    ds_read_b32 v218, v6 offset:48384
    ds_read_b32 v219, v6 offset:64768
    s_waitcnt vmcnt(11)
    s_waitcnt lgkmcnt(15)
    v_mfma_f32_32x32x16_bf16 v[144:159], a[8:11], v[36:39], v[144:159]
    ds_read_b64_tr_b16 a[28:29], v11 offset:21568
    ds_read_b64_tr_b16 a[30:31], v11 offset:23104
    buffer_load_dwordx4 v[68:71], v1, s[56:59], s77 offen offset:1024 sc1
    ds_read_b32 v220, v6 offset:15872
    ds_read_b32 v221, v6 offset:32256
    s_waitcnt lgkmcnt(15)
    v_mfma_f32_32x32x16_bf16 v[160:175], a[12:15], v[36:39], v[160:175]
    ds_read_b64_tr_b16 a[0:1], v11 offset:128
    ds_read_b64_tr_b16 a[2:3], v11 offset:1664
    ds_read_b32 v222, v6 offset:48640
    ds_read_b32 v223, v6 offset:65024
    s_waitcnt vmcnt(11)
    s_waitcnt lgkmcnt(15)
    v_mfma_f32_32x32x16_bf16 v[144:159], a[16:19], v[40:43], v[144:159]
    ds_read_b64_tr_b16 a[4:5], v11 offset:24576
    ds_read_b64_tr_b16 a[6:7], v11 offset:26112
    buffer_load_dwordx4 v[72:75], v1, s[56:59], s77 offen offset:2048 sc1
    s_waitcnt lgkmcnt(15)
    v_mfma_f32_32x32x16_bf16 v[160:175], a[20:23], v[40:43], v[160:175]
    ds_read_b64_tr_b16 a[8:9], v11 offset:24640
    ds_read_b64_tr_b16 a[10:11], v11 offset:26176
    s_waitcnt vmcnt(11)
    s_waitcnt lgkmcnt(14)
    v_mfma_f32_32x32x16_bf16 v[144:159], a[24:27], v[44:47], v[144:159]
    ds_read_b64_tr_b16 a[12:13], v11 offset:27648
    ds_read_b64_tr_b16 a[14:15], v11 offset:29184
    buffer_load_dwordx4 v[76:79], v1, s[56:59], s77 offen offset:3072 sc1
    s_waitcnt lgkmcnt(12)
    v_mfma_f32_32x32x16_bf16 v[160:175], a[28:31], v[44:47], v[160:175]
    ds_read_b64_tr_b16 a[16:17], v11 offset:27712
    ds_read_b64_tr_b16 a[18:19], v11 offset:29248
    s_waitcnt lgkmcnt(10)
    v_mfma_f32_32x32x16_bf16 v[176:191], a[0:3], v[16:19], 0
    ds_read_b64_tr_b16 a[20:21], v11 offset:30720
    ds_read_b64_tr_b16 a[22:23], v11 offset:32256
    s_waitcnt lgkmcnt(10)
    v_pk_add_f32 v[212:213], v[212:213], v[214:215]
    v_add_f32 v212, v212, v213
    s_waitcnt vmcnt(11)
    s_waitcnt lgkmcnt(8)
    v_mfma_f32_32x32x16_bf16 v[144:159], a[4:7], v[48:51], v[144:159]
    ds_read_b64_tr_b16 a[24:25], v11 offset:30784
    ds_read_b64_tr_b16 a[26:27], v11 offset:32320
    s_add_u32 s77, s72, 0x4000
    buffer_load_dwordx4 v[80:83], v1, s[56:59], s77 offen offset:0 sc1
    v_cvt_pk_bf16_f32 v228, v212, v212
    v_and_b32 v229, s71, v228
    s_waitcnt lgkmcnt(8)
    v_mfma_f32_32x32x16_bf16 v[160:175], a[8:11], v[48:51], v[160:175]
    ds_read_b64_tr_b16 a[28:29], v11 offset:33792
    ds_read_b64_tr_b16 a[30:31], v11 offset:35328
    v_sub_f32 v229, v212, v229
    v_cvt_pk_bf16_f32 v229, v229, 0
    s_waitcnt vmcnt(11)
    s_waitcnt lgkmcnt(8)
    v_mfma_f32_32x32x16_bf16 v[144:159], a[12:15], v[52:55], v[144:159]
    ds_read_b64_tr_b16 a[0:1], v11 offset:33856
    ds_read_b64_tr_b16 a[2:3], v11 offset:35392
    buffer_load_dwordx4 v[84:87], v1, s[56:59], s77 offen offset:1024 sc1
    v_mov_b32 v230, 0
    v_mov_b32 v231, 0
    s_waitcnt lgkmcnt(8)
    v_mfma_f32_32x32x16_bf16 v[160:175], a[16:19], v[52:55], v[160:175]
    ds_read_b64_tr_b16 a[4:5], v11 offset:36864
    ds_read_b64_tr_b16 a[6:7], v11 offset:38400
    ds_read_b64_tr_b16 a[64:65], v2 offset:0
    ds_read_b64_tr_b16 a[68:69], v3 offset:0
    v_pk_add_f32 v[216:217], v[216:217], v[218:219]
    v_add_f32 v216, v216, v217
    s_waitcnt vmcnt(7)
    s_waitcnt lgkmcnt(10)
    v_mfma_f32_32x32x16_bf16 v[144:159], a[20:23], v[56:59], v[144:159]
    ds_read_b64_tr_b16 a[8:9], v11 offset:36928
    ds_read_b64_tr_b16 a[10:11], v11 offset:38464
    buffer_load_dwordx4 v[88:91], v1, s[56:59], s77 offen offset:2048 sc1
    ds_read_b64_tr_b16 a[66:67], v2 offset:1024
    ds_read_b64_tr_b16 a[70:71], v3 offset:1024
    v_cvt_pk_bf16_f32 v232, v216, v216
    v_and_b32 v233, s71, v232
    s_waitcnt lgkmcnt(12)
    v_mfma_f32_32x32x16_bf16 v[160:175], a[24:27], v[56:59], v[160:175]
    ds_read_b64_tr_b16 a[12:13], v11 offset:39936
    ds_read_b64_tr_b16 a[14:15], v11 offset:41472
    ds_read_b64_tr_b16 a[72:73], v2 offset:2048
    ds_read_b64_tr_b16 a[76:77], v3 offset:2048
    v_sub_f32 v233, v216, v233
    v_cvt_pk_bf16_f32 v233, v233, 0
    s_waitcnt vmcnt(7)
    s_waitcnt lgkmcnt(14)
    v_mfma_f32_32x32x16_bf16 v[144:159], a[28:31], v[60:63], v[144:159]
    ds_read_b64_tr_b16 a[16:17], v11 offset:40000
    ds_read_b64_tr_b16 a[18:19], v11 offset:41536
    buffer_load_dwordx4 v[92:95], v1, s[56:59], s77 offen offset:3072 sc1
    ds_read_b64_tr_b16 a[74:75], v2 offset:3072
    ds_read_b64_tr_b16 a[78:79], v3 offset:3072
    v_mov_b32 v234, 0
    v_mov_b32 v235, 0
    s_waitcnt lgkmcnt(15)
    v_mfma_f32_32x32x16_bf16 v[160:175], a[0:3], v[60:63], v[160:175]
    ds_read_b64_tr_b16 a[20:21], v11 offset:43008
    ds_read_b64_tr_b16 a[22:23], v11 offset:44544
    ds_read_b64_tr_b16 a[80:81], v2 offset:4096
    ds_read_b64_tr_b16 a[84:85], v3 offset:4096
    v_pk_add_f32 v[220:221], v[220:221], v[222:223]
    v_add_f32 v220, v220, v221
    s_waitcnt vmcnt(7)
    s_waitcnt lgkmcnt(15)
    v_mfma_f32_32x32x16_bf16 v[144:159], a[4:7], v[64:67], v[144:159]
    ds_read_b64_tr_b16 a[24:25], v11 offset:43072
    ds_read_b64_tr_b16 a[26:27], v11 offset:44608
    s_add_u32 s77, s72, 0x5000
    buffer_load_dwordx4 v[96:99], v1, s[56:59], s77 offen offset:0 sc1
    ds_read_b64_tr_b16 a[82:83], v2 offset:5120
    ds_read_b64_tr_b16 a[86:87], v3 offset:5120
    v_cvt_pk_bf16_f32 v236, v220, v220
    v_and_b32 v237, s71, v236
    s_waitcnt lgkmcnt(15)
    v_mfma_f32_32x32x16_bf16 v[160:175], a[8:11], v[64:67], v[160:175]
    ds_read_b64_tr_b16 a[28:29], v11 offset:46080
    ds_read_b64_tr_b16 a[30:31], v11 offset:47616
    ds_read_b64_tr_b16 a[88:89], v2 offset:6144
    ds_read_b64_tr_b16 a[92:93], v3 offset:6144
    v_sub_f32 v237, v220, v237
    v_cvt_pk_bf16_f32 v237, v237, 0
    s_waitcnt vmcnt(7)
    s_waitcnt lgkmcnt(15)
    v_mfma_f32_32x32x16_bf16 v[144:159], a[12:15], v[68:71], v[144:159]
    ds_read_b64_tr_b16 a[0:1], v11 offset:46144
    ds_read_b64_tr_b16 a[2:3], v11 offset:47680
    buffer_load_dwordx4 v[100:103], v1, s[56:59], s77 offen offset:1024 sc1
    ds_read_b64_tr_b16 a[90:91], v2 offset:7168
    ds_read_b64_tr_b16 a[94:95], v3 offset:7168
    v_mov_b32 v238, 0
    v_mov_b32 v239, 0
    s_waitcnt lgkmcnt(15)
    v_mfma_f32_32x32x16_bf16 v[160:175], a[16:19], v[68:71], v[160:175]
    ds_read_b64_tr_b16 a[4:5], v11 offset:3200
    ds_read_b64_tr_b16 a[6:7], v11 offset:4736
    ds_read_b64_tr_b16 a[96:97], v2 offset:8192
    ds_read_b64_tr_b16 a[100:101], v3 offset:8192
    s_waitcnt vmcnt(7)
    s_waitcnt lgkmcnt(15)
    v_mfma_f32_32x32x16_bf16 v[144:159], a[20:23], v[72:75], v[144:159]
    ds_read_b64_tr_b16 a[8:9], v12 offset:0
    ds_read_b64_tr_b16 a[10:11], v12 offset:1536
    buffer_load_dwordx4 v[104:107], v1, s[56:59], s77 offen offset:2048 sc1
    ds_read_b64_tr_b16 a[98:99], v2 offset:9216
    ds_read_b64_tr_b16 a[102:103], v3 offset:9216
    s_waitcnt lgkmcnt(15)
    v_mfma_f32_32x32x16_bf16 v[160:175], a[24:27], v[72:75], v[160:175]
    ds_read_b64_tr_b16 a[12:13], v12 offset:64
    ds_read_b64_tr_b16 a[14:15], v12 offset:1600
    s_lshl_b32 s75, s64, 6
    s_add_u32 s76, s75, s5
    s_lshl_b32 s76, s76, 11
    s_add_u32 s76, s76, 0x8000
    s_add_u32 s75, s75, 43
    s_lshl_b32 s75, s75, 11
    s_add_u32 s75, s75, 0x8000
    s_add_u32 s73, s76, 4096
    s_cmp_ge_u32 s63, 11
    s_cselect_b32 s75, s75, s73
    ds_read_b64_tr_b16 a[104:105], v2 offset:10240
    ds_read_b64_tr_b16 a[108:109], v3 offset:10240
    v_pk_add_f32 v[192:193], v[192:193], v[194:195]
    s_waitcnt vmcnt(7)
    s_waitcnt lgkmcnt(15)
    v_mfma_f32_32x32x16_bf16 v[144:159], a[28:31], v[76:79], v[144:159]
    ds_read_b64_tr_b16 a[16:17], v12 offset:3072
    ds_read_b64_tr_b16 a[18:19], v12 offset:4608
    buffer_load_dwordx4 v[108:111], v1, s[56:59], s77 offen offset:3072 sc1
    ds_read_b64_tr_b16 a[106:107], v2 offset:11264
    ds_read_b64_tr_b16 a[110:111], v3 offset:11264
    v_pk_add_f32 v[192:193], v[192:193], v[196:197]
    v_pk_add_f32 v[192:193], v[192:193], v[198:199]
    s_waitcnt lgkmcnt(15)
    v_mfma_f32_32x32x16_bf16 v[160:175], a[0:3], v[76:79], v[160:175]
    ds_read_b64_tr_b16 a[20:21], v12 offset:3136
    ds_read_b64_tr_b16 a[22:23], v12 offset:4672
    ds_read_b64_tr_b16 a[112:113], v2 offset:12288
    ds_read_b64_tr_b16 a[116:117], v3 offset:12288
    v_pk_add_f32 v[192:193], v[192:193], v[200:201]
    v_pk_add_f32 v[192:193], v[192:193], v[202:203]
    s_waitcnt lgkmcnt(15)
    v_mfma_f32_32x32x16_bf16 v[176:191], a[4:7], v[20:23], v[176:191]
    ds_read_b64_tr_b16 a[24:25], v12 offset:6144
    ds_read_b64_tr_b16 a[26:27], v12 offset:7680
    ds_read_b64_tr_b16 a[114:115], v2 offset:13312
    ds_read_b64_tr_b16 a[118:119], v3 offset:13312
    v_pk_add_f32 v[192:193], v[192:193], v[204:205]
    v_pk_add_f32 v[192:193], v[192:193], v[206:207]
    s_waitcnt vmcnt(7)
    s_waitcnt lgkmcnt(15)
    v_mfma_f32_32x32x16_bf16 v[144:159], a[8:11], v[80:83], v[144:159]
    ds_read_b64_tr_b16 a[28:29], v12 offset:6208
    ds_read_b64_tr_b16 a[30:31], v12 offset:7744
    s_add_u32 s77, s72, 0x6000
    buffer_load_dwordx4 v[112:115], v1, s[56:59], s77 offen offset:0 sc1
    ds_read_b64_tr_b16 a[120:121], v2 offset:14336
    ds_read_b64_tr_b16 a[124:125], v3 offset:14336
    v_mov_b32 v194, v192
    v_mov_b32 v195, v193
    s_waitcnt lgkmcnt(15)
    v_mfma_f32_32x32x16_bf16 v[160:175], a[12:15], v[80:83], v[160:175]
    ds_read_b64_tr_b16 a[0:1], v12 offset:9216
    ds_read_b64_tr_b16 a[2:3], v12 offset:10752
    v_permlane32_swap_b32 v192, v194
    v_permlane32_swap_b32 v193, v195
    s_waitcnt vmcnt(7)
    s_waitcnt lgkmcnt(15)
    v_mfma_f32_32x32x16_bf16 v[144:159], a[16:19], v[84:87], v[144:159]
    ds_read_b64_tr_b16 a[4:5], v12 offset:9280
    ds_read_b64_tr_b16 a[6:7], v12 offset:10816
    buffer_load_dwordx4 v[116:119], v1, s[56:59], s77 offen offset:1024 sc1
    v_pk_add_f32 v[192:193], v[192:193], v[194:195]
    v_mul_f32 v192, 0xbb000000, v192
    s_waitcnt lgkmcnt(14)
    v_mfma_f32_32x32x16_bf16 v[160:175], a[20:23], v[84:87], v[160:175]
    ds_read_b64_tr_b16 a[8:9], v12 offset:12288
    ds_read_b64_tr_b16 a[10:11], v12 offset:13824
    v_mul_f32 v193, 0x3b000000, v193
    v_fma_f32 v193, -v192, v192, v193
    s_waitcnt vmcnt(7)
    s_waitcnt lgkmcnt(12)
    v_mfma_f32_32x32x16_bf16 v[144:159], a[24:27], v[88:91], v[144:159]
    ds_read_b64_tr_b16 a[12:13], v12 offset:12352
    ds_read_b64_tr_b16 a[14:15], v12 offset:13888
    buffer_load_dwordx4 v[120:123], v1, s[56:59], s77 offen offset:2048 sc1
    v_max_f32 v193, 0, v193
    v_add_f32 v193, 0x3727c5ac, v193
    s_waitcnt lgkmcnt(10)
    v_mfma_f32_32x32x16_bf16 v[160:175], a[28:31], v[88:91], v[160:175]
    ds_read_b64_tr_b16 a[16:17], v12 offset:15360
    ds_read_b64_tr_b16 a[18:19], v12 offset:16896
    v_rsq_f32 v194, v193
    v_cmp_gt_u32 vcc, 32, v0
    s_waitcnt vmcnt(7)
    s_waitcnt lgkmcnt(8)
    v_mfma_f32_32x32x16_bf16 v[144:159], a[0:3], v[92:95], v[144:159]
    ds_read_b64_tr_b16 a[20:21], v12 offset:15424
    ds_read_b64_tr_b16 a[22:23], v12 offset:16960
    buffer_load_dwordx4 v[124:127], v1, s[56:59], s77 offen offset:3072 sc1
    v_mul_f32 v193, v193, v194
    v_cndmask_b32 v192, v193, v192, vcc
    s_waitcnt lgkmcnt(8)
    v_mfma_f32_32x32x16_bf16 v[160:175], a[4:7], v[92:95], v[160:175]
    ds_read_b64_tr_b16 a[24:25], v12 offset:18432
    ds_read_b64_tr_b16 a[26:27], v12 offset:19968
    v_cvt_pk_bf16_f32 v209, v192, 0
    v_lshlrev_b32 v193, 16, v209
    s_waitcnt vmcnt(7)
    s_waitcnt lgkmcnt(8)
    v_mfma_f32_32x32x16_bf16 v[144:159], a[8:11], v[96:99], v[144:159]
    ds_read_b64_tr_b16 a[28:29], v12 offset:18496
    ds_read_b64_tr_b16 a[30:31], v12 offset:20032
    s_add_u32 s77, s72, 0x7000
    buffer_load_dwordx4 v[128:131], v1, s[56:59], s77 offen offset:0 sc1
    v_sub_f32 v193, v192, v193
    v_cvt_pk_bf16_f32 v208, v192, v193
    s_waitcnt lgkmcnt(8)
    v_mfma_f32_32x32x16_bf16 v[160:175], a[12:15], v[96:99], v[160:175]
    ds_read_b64_tr_b16 a[0:1], v12 offset:21504
    ds_read_b64_tr_b16 a[2:3], v12 offset:23040
    v_mov_b32 v210, 0
    v_mov_b32 v211, 0
    s_waitcnt vmcnt(7)
    s_waitcnt lgkmcnt(8)
    v_mfma_f32_32x32x16_bf16 v[144:159], a[16:19], v[100:103], v[144:159]
    ds_read_b64_tr_b16 a[4:5], v12 offset:21568
    ds_read_b64_tr_b16 a[6:7], v12 offset:23104
    buffer_load_dwordx4 v[132:135], v1, s[56:59], s77 offen offset:1024 sc1
    v_lshl_add_u32 v6, v0, 2, s68
    s_waitcnt lgkmcnt(8)
    v_mfma_f32_32x32x16_bf16 v[160:175], a[20:23], v[100:103], v[160:175]
    ds_read_b64_tr_b16 a[8:9], v11 offset:6272
    ds_read_b64_tr_b16 a[10:11], v11 offset:7808
    s_waitcnt vmcnt(7)
    s_waitcnt lgkmcnt(8)
    v_mfma_f32_32x32x16_bf16 v[144:159], a[24:27], v[104:107], v[144:159]
    ds_read_b64_tr_b16 a[12:13], v12 offset:24576
    ds_read_b64_tr_b16 a[14:15], v12 offset:26112
    buffer_load_dwordx4 v[136:139], v1, s[56:59], s77 offen offset:2048 sc1
    s_waitcnt lgkmcnt(8)
    v_mfma_f32_32x32x16_bf16 v[160:175], a[28:31], v[104:107], v[160:175]
    ds_read_b64_tr_b16 a[16:17], v12 offset:24640
    ds_read_b64_tr_b16 a[18:19], v12 offset:26176
    s_waitcnt vmcnt(7)
    s_waitcnt lgkmcnt(8)
    v_mfma_f32_32x32x16_bf16 v[144:159], a[0:3], v[108:111], v[144:159]
    ds_read_b64_tr_b16 a[20:21], v12 offset:27648
    ds_read_b64_tr_b16 a[22:23], v12 offset:29184
    buffer_load_dwordx4 v[140:143], v1, s[56:59], s77 offen offset:3072 sc1
    s_waitcnt lgkmcnt(8)
    v_mfma_f32_32x32x16_bf16 v[160:175], a[4:7], v[108:111], v[160:175]
    ds_read_b64_tr_b16 a[24:25], v12 offset:27712
    ds_read_b64_tr_b16 a[26:27], v12 offset:29248
    s_waitcnt lgkmcnt(8)
    v_mfma_f32_32x32x16_bf16 v[176:191], a[8:11], v[24:27], v[176:191]
    ds_read_b64_tr_b16 a[28:29], v12 offset:30720
    ds_read_b64_tr_b16 a[30:31], v12 offset:32256
    s_add_u32 m0, s68, 0x0
    s_add_u32 s79, s13, 0x24000
    buffer_load_dwordx4 v4, s[44:47], s79 offen lds
    s_waitcnt vmcnt(8)
    s_waitcnt lgkmcnt(8)
    v_mfma_f32_32x32x16_bf16 v[144:159], a[12:15], v[112:115], v[144:159]
    ds_read_b64_tr_b16 a[0:1], v12 offset:30784
    ds_read_b64_tr_b16 a[2:3], v12 offset:32320
    s_waitcnt lgkmcnt(8)
    v_mfma_f32_32x32x16_bf16 v[160:175], a[16:19], v[112:115], v[160:175]
    ds_read_b64_tr_b16 a[4:5], v12 offset:33792
    ds_read_b64_tr_b16 a[6:7], v12 offset:35328
    s_add_u32 m0, s68, 0x400
    s_add_u32 s79, s13, 0x26000
    buffer_load_dwordx4 v4, s[44:47], s79 offen lds
    s_waitcnt vmcnt(8)
    s_waitcnt lgkmcnt(8)
    v_mfma_f32_32x32x16_bf16 v[144:159], a[20:23], v[116:119], v[144:159]
    ds_read_b64_tr_b16 a[8:9], v12 offset:33856
    ds_read_b64_tr_b16 a[10:11], v12 offset:35392
    s_waitcnt lgkmcnt(8)
    v_mfma_f32_32x32x16_bf16 v[160:175], a[24:27], v[116:119], v[160:175]
    ds_read_b64_tr_b16 a[12:13], v12 offset:36864
    ds_read_b64_tr_b16 a[14:15], v12 offset:38400
    s_add_u32 m0, s68, 0x800
    s_add_u32 s79, s13, 0x28000
    buffer_load_dwordx4 v4, s[44:47], s79 offen lds
    s_waitcnt vmcnt(8)
    s_waitcnt lgkmcnt(8)
    v_mfma_f32_32x32x16_bf16 v[144:159], a[28:31], v[120:123], v[144:159]
    ds_read_b64_tr_b16 a[16:17], v12 offset:36928
    ds_read_b64_tr_b16 a[18:19], v12 offset:38464
    s_waitcnt lgkmcnt(8)
    v_mfma_f32_32x32x16_bf16 v[160:175], a[0:3], v[120:123], v[160:175]
    ds_read_b64_tr_b16 a[20:21], v12 offset:39936
    ds_read_b64_tr_b16 a[22:23], v12 offset:41472
    s_add_u32 m0, s68, 0xc00
    s_add_u32 s79, s13, 0x2a000
    buffer_load_dwordx4 v4, s[44:47], s79 offen lds
    s_waitcnt vmcnt(8)
    s_waitcnt lgkmcnt(8)
    v_mfma_f32_32x32x16_bf16 v[144:159], a[4:7], v[124:127], v[144:159]
    ds_read_b64_tr_b16 a[24:25], v12 offset:40000
    ds_read_b64_tr_b16 a[26:27], v12 offset:41536
    s_waitcnt lgkmcnt(8)
    v_mfma_f32_32x32x16_bf16 v[160:175], a[8:11], v[124:127], v[160:175]
    ds_read_b64_tr_b16 a[28:29], v12 offset:43008
    ds_read_b64_tr_b16 a[30:31], v12 offset:44544
    s_add_u32 m0, s68, 0x1000
    s_add_u32 s79, s13, 0x2c000
    buffer_load_dwordx4 v4, s[44:47], s79 offen lds
    s_waitcnt vmcnt(8)
    s_waitcnt lgkmcnt(8)
    v_mfma_f32_32x32x16_bf16 v[144:159], a[12:15], v[128:131], v[144:159]
    ds_read_b64_tr_b16 a[0:1], v12 offset:43072
    ds_read_b64_tr_b16 a[2:3], v12 offset:44608
    s_waitcnt lgkmcnt(8)
    v_mfma_f32_32x32x16_bf16 v[160:175], a[16:19], v[128:131], v[160:175]
    ds_read_b64_tr_b16 a[4:5], v12 offset:46080
    ds_read_b64_tr_b16 a[6:7], v12 offset:47616
    s_add_u32 m0, s68, 0x1400
    s_add_u32 s79, s13, 0x2e000
    buffer_load_dwordx4 v4, s[44:47], s79 offen lds
    s_waitcnt vmcnt(8)
    s_waitcnt lgkmcnt(8)
    v_mfma_f32_32x32x16_bf16 v[144:159], a[20:23], v[132:135], v[144:159]
    ds_read_b64_tr_b16 a[8:9], v12 offset:46144
    ds_read_b64_tr_b16 a[10:11], v12 offset:47680
    s_waitcnt lgkmcnt(8)
    v_mfma_f32_32x32x16_bf16 v[160:175], a[24:27], v[132:135], v[160:175]
    ds_read_b64_tr_b16 a[12:13], v11 offset:9344
    ds_read_b64_tr_b16 a[14:15], v11 offset:10880
    s_add_u32 m0, s68, 0x1800
    s_add_u32 s79, s13, 0x30000
    buffer_load_dwordx4 v4, s[44:47], s79 offen lds
    s_waitcnt vmcnt(8)
    s_waitcnt lgkmcnt(8)
    v_mfma_f32_32x32x16_bf16 v[144:159], a[28:31], v[136:139], v[144:159]
    ds_read_b64_tr_b16 a[16:17], v11 offset:12416
    ds_read_b64_tr_b16 a[18:19], v11 offset:13952
    s_waitcnt lgkmcnt(8)
    v_mfma_f32_32x32x16_bf16 v[160:175], a[0:3], v[136:139], v[160:175]
    ds_read_b64_tr_b16 a[20:21], v11 offset:15488
    ds_read_b64_tr_b16 a[22:23], v11 offset:17024
    s_add_u32 m0, s68, 0x1c00
    s_add_u32 s79, s13, 0x32000
    buffer_load_dwordx4 v4, s[44:47], s79 offen lds
    s_waitcnt vmcnt(8)
    s_waitcnt lgkmcnt(8)
    v_mfma_f32_32x32x16_bf16 v[144:159], a[4:7], v[140:143], v[144:159]
    ds_read_b64_tr_b16 a[24:25], v11 offset:18560
    ds_read_b64_tr_b16 a[26:27], v11 offset:20096
    ds_write_b32 v6, v194 offset:16128
    v_mfma_f32_32x32x16_bf16 v[144:159], v[228:231], v[208:211], v[144:159]
    s_waitcnt lgkmcnt(9)
    v_mfma_f32_32x32x16_bf16 v[160:175], a[8:11], v[140:143], v[160:175]
    ds_read_b64_tr_b16 a[28:29], v11 offset:21632
    ds_read_b64_tr_b16 a[30:31], v11 offset:23168
    v_mfma_f32_32x32x16_bf16 v[160:175], v[232:235], v[208:211], v[160:175]
    s_add_u32 m0, s68, 0x2000
    s_add_u32 s79, s13, 0x34000
    buffer_load_dwordx4 v4, s[44:47], s79 offen lds
    s_waitcnt lgkmcnt(9)
    v_mfma_f32_32x32x16_bf16 v[176:191], a[12:15], v[28:31], v[176:191]
    ds_read_b64_tr_b16 a[0:1], v11 offset:24704
    ds_read_b64_tr_b16 a[2:3], v11 offset:26240
    v_cvt_pk_bf16_f32 v144, v144, v145
    v_cvt_pk_bf16_f32 v145, v146, v147
    s_waitcnt lgkmcnt(9)
    v_mfma_f32_32x32x16_bf16 v[176:191], a[16:19], v[32:35], v[176:191]
    ds_read_b64_tr_b16 a[4:5], v11 offset:27776
    ds_read_b64_tr_b16 a[6:7], v11 offset:29312
    s_add_u32 m0, s68, 0x2400
    s_add_u32 s79, s13, 0x36000
    buffer_load_dwordx4 v4, s[44:47], s79 offen lds
    v_cvt_pk_bf16_f32 v146, v148, v149
    v_cvt_pk_bf16_f32 v147, v150, v151
    s_waitcnt lgkmcnt(9)
    v_mfma_f32_32x32x16_bf16 v[176:191], a[20:23], v[36:39], v[176:191]
    ds_read_b64_tr_b16 a[8:9], v11 offset:30848
    ds_read_b64_tr_b16 a[10:11], v11 offset:32384
    v_pk_max_i16 v144, v144, 0
    v_pk_max_i16 v145, v145, 0
    s_waitcnt lgkmcnt(9)
    v_mfma_f32_32x32x16_bf16 v[176:191], a[24:27], v[40:43], v[176:191]
    ds_read_b64_tr_b16 a[12:13], v11 offset:33920
    ds_read_b64_tr_b16 a[14:15], v11 offset:35456
    s_add_u32 m0, s68, 0x2800
    s_add_u32 s79, s13, 0x38000
    buffer_load_dwordx4 v4, s[44:47], s79 offen lds
    v_pk_max_i16 v146, v146, 0
    v_pk_max_i16 v147, v147, 0
    s_waitcnt lgkmcnt(8)
    v_mfma_f32_32x32x16_bf16 v[176:191], a[28:31], v[44:47], v[176:191]
    ds_read_b64_tr_b16 a[16:17], v11 offset:36992
    ds_read_b64_tr_b16 a[18:19], v11 offset:38528
    buffer_store_dwordx4 v[144:147], v1, s[56:59], s76 offen offset:0 sc1
    v_cvt_pk_bf16_f32 v148, v152, v153
    s_waitcnt lgkmcnt(8)
    v_mfma_f32_32x32x16_bf16 v[176:191], a[0:3], v[48:51], v[176:191]
    ds_read_b64_tr_b16 a[20:21], v11 offset:40064
    ds_read_b64_tr_b16 a[22:23], v11 offset:41600
    s_add_u32 m0, s68, 0x2c00
    s_add_u32 s79, s13, 0x3a000
    buffer_load_dwordx4 v4, s[44:47], s79 offen lds
    v_cvt_pk_bf16_f32 v149, v154, v155
    v_cvt_pk_bf16_f32 v150, v156, v157
    s_waitcnt lgkmcnt(8)
    v_mfma_f32_32x32x16_bf16 v[176:191], a[4:7], v[52:55], v[176:191]
    ds_read_b64_tr_b16 a[24:25], v11 offset:43136
    ds_read_b64_tr_b16 a[26:27], v11 offset:44672
    v_cvt_pk_bf16_f32 v151, v158, v159
    v_pk_max_i16 v148, v148, 0
    s_waitcnt lgkmcnt(8)
    v_mfma_f32_32x32x16_bf16 v[176:191], a[8:11], v[56:59], v[176:191]
    ds_read_b64_tr_b16 a[28:29], v11 offset:46208
    ds_read_b64_tr_b16 a[30:31], v11 offset:47744
    s_add_u32 m0, s68, 0x3000
    s_add_u32 s79, s13, 0x3c000
    buffer_load_dwordx4 v4, s[44:47], s79 offen lds
    v_pk_max_i16 v149, v149, 0
    v_pk_max_i16 v150, v150, 0
    s_waitcnt lgkmcnt(8)
    v_mfma_f32_32x32x16_bf16 v[176:191], a[12:15], v[60:63], v[176:191]
    ds_read_b64_tr_b16 a[0:1], v12 offset:128
    ds_read_b64_tr_b16 a[2:3], v12 offset:1664
    v_pk_max_i16 v151, v151, 0
    buffer_store_dwordx4 v[148:151], v1, s[56:59], s76 offen offset:1024 sc1
    s_waitcnt lgkmcnt(8)
    v_mfma_f32_32x32x16_bf16 v[176:191], a[16:19], v[64:67], v[176:191]
    ds_read_b64_tr_b16 a[4:5], v12 offset:3200
    ds_read_b64_tr_b16 a[6:7], v12 offset:4736
    s_add_u32 m0, s68, 0x3400
    s_add_u32 s79, s13, 0x3e000
    buffer_load_dwordx4 v4, s[44:47], s79 offen lds
    v_cvt_pk_bf16_f32 v160, v160, v161
    v_cvt_pk_bf16_f32 v161, v162, v163
    s_waitcnt lgkmcnt(8)
    v_mfma_f32_32x32x16_bf16 v[176:191], a[20:23], v[68:71], v[176:191]
    ds_read_b64_tr_b16 a[8:9], v12 offset:6272
    ds_read_b64_tr_b16 a[10:11], v12 offset:7808
    v_cvt_pk_bf16_f32 v162, v164, v165
    v_cvt_pk_bf16_f32 v163, v166, v167
    s_waitcnt lgkmcnt(8)
    v_mfma_f32_32x32x16_bf16 v[176:191], a[24:27], v[72:75], v[176:191]
    ds_read_b64_tr_b16 a[12:13], v12 offset:9344
    ds_read_b64_tr_b16 a[14:15], v12 offset:10880
    s_add_u32 m0, s68, 0x3800
    s_add_u32 s79, s13, 0x40000
    buffer_load_dwordx4 v4, s[44:47], s79 offen lds
    v_pk_max_i16 v160, v160, 0
    v_pk_max_i16 v161, v161, 0
    s_waitcnt lgkmcnt(8)
    v_mfma_f32_32x32x16_bf16 v[176:191], a[28:31], v[76:79], v[176:191]
    ds_read_b64_tr_b16 a[16:17], v12 offset:12416
    ds_read_b64_tr_b16 a[18:19], v12 offset:13952
    v_pk_max_i16 v162, v162, 0
    v_pk_max_i16 v163, v163, 0
    s_waitcnt lgkmcnt(8)
    v_mfma_f32_32x32x16_bf16 v[176:191], a[0:3], v[80:83], v[176:191]
    ds_read_b64_tr_b16 a[20:21], v12 offset:15488
    ds_read_b64_tr_b16 a[22:23], v12 offset:17024
    buffer_store_dwordx4 v[160:163], v1, s[56:59], s76 offen offset:2048 sc1
    v_cvt_pk_bf16_f32 v164, v168, v169
    s_waitcnt lgkmcnt(8)
    v_mfma_f32_32x32x16_bf16 v[176:191], a[4:7], v[84:87], v[176:191]
    ds_read_b64_tr_b16 a[24:25], v12 offset:18560
    ds_read_b64_tr_b16 a[26:27], v12 offset:20096
    v_cvt_pk_bf16_f32 v165, v170, v171
    v_cvt_pk_bf16_f32 v166, v172, v173
    s_waitcnt lgkmcnt(8)
    v_mfma_f32_32x32x16_bf16 v[176:191], a[8:11], v[88:91], v[176:191]
    ds_read_b64_tr_b16 a[28:29], v12 offset:21632
    ds_read_b64_tr_b16 a[30:31], v12 offset:23168
    v_cvt_pk_bf16_f32 v167, v174, v175
    v_pk_max_i16 v164, v164, 0
    s_waitcnt lgkmcnt(8)
    v_mfma_f32_32x32x16_bf16 v[176:191], a[12:15], v[92:95], v[176:191]
    ds_read_b64_tr_b16 a[0:1], v12 offset:24704
    ds_read_b64_tr_b16 a[2:3], v12 offset:26240
    v_pk_max_i16 v165, v165, 0
    v_pk_max_i16 v166, v166, 0
    s_waitcnt lgkmcnt(8)
    v_mfma_f32_32x32x16_bf16 v[176:191], a[16:19], v[96:99], v[176:191]
    ds_read_b64_tr_b16 a[4:5], v12 offset:27776
    ds_read_b64_tr_b16 a[6:7], v12 offset:29312
    v_pk_max_i16 v167, v167, 0
    buffer_store_dwordx4 v[164:167], v1, s[56:59], s76 offen offset:3072 sc1
    s_waitcnt lgkmcnt(8)
    v_mfma_f32_32x32x16_bf16 v[176:191], a[20:23], v[100:103], v[176:191]
    ds_read_b64_tr_b16 a[8:9], v12 offset:30848
    ds_read_b64_tr_b16 a[10:11], v12 offset:32384
    s_waitcnt lgkmcnt(8)
    v_mfma_f32_32x32x16_bf16 v[176:191], a[24:27], v[104:107], v[176:191]
    ds_read_b64_tr_b16 a[12:13], v12 offset:33920
    ds_read_b64_tr_b16 a[14:15], v12 offset:35456
    s_waitcnt lgkmcnt(8)
    v_mfma_f32_32x32x16_bf16 v[176:191], a[28:31], v[108:111], v[176:191]
    ds_read_b64_tr_b16 a[16:17], v12 offset:36992
    ds_read_b64_tr_b16 a[18:19], v12 offset:38528
    s_waitcnt lgkmcnt(8)
    v_mfma_f32_32x32x16_bf16 v[176:191], a[0:3], v[112:115], v[176:191]
    ds_read_b64_tr_b16 a[20:21], v12 offset:40064
    ds_read_b64_tr_b16 a[22:23], v12 offset:41600
    s_waitcnt lgkmcnt(8)
    v_mfma_f32_32x32x16_bf16 v[176:191], a[4:7], v[116:119], v[176:191]
    ds_read_b64_tr_b16 a[24:25], v12 offset:43136
    ds_read_b64_tr_b16 a[26:27], v12 offset:44672
    s_waitcnt lgkmcnt(8)
    v_mfma_f32_32x32x16_bf16 v[176:191], a[8:11], v[120:123], v[176:191]
    ds_read_b64_tr_b16 a[28:29], v12 offset:46208
    ds_read_b64_tr_b16 a[30:31], v12 offset:47744
    s_waitcnt lgkmcnt(8)
    v_mfma_f32_32x32x16_bf16 v[176:191], a[12:15], v[124:127], v[176:191]
    s_waitcnt lgkmcnt(6)
    v_mfma_f32_32x32x16_bf16 v[176:191], a[16:19], v[128:131], v[176:191]
    s_waitcnt lgkmcnt(4)
    v_mfma_f32_32x32x16_bf16 v[176:191], a[20:23], v[132:135], v[176:191]
    s_waitcnt lgkmcnt(2)
    v_mfma_f32_32x32x16_bf16 v[176:191], a[24:27], v[136:139], v[176:191]
    s_waitcnt lgkmcnt(0)
    v_mfma_f32_32x32x16_bf16 v[176:191], a[28:31], v[140:143], v[176:191]
    v_mfma_f32_32x32x16_bf16 v[176:191], v[236:239], v[208:211], v[176:191]
    s_nop 11
    v_cvt_pk_bf16_f32 v176, v176, v177
    v_cvt_pk_bf16_f32 v177, v178, v179
    v_cvt_pk_bf16_f32 v178, v180, v181
    v_cvt_pk_bf16_f32 v179, v182, v183
    v_pk_max_i16 v176, v176, 0
    v_pk_max_i16 v177, v177, 0
    v_pk_max_i16 v178, v178, 0
    v_pk_max_i16 v179, v179, 0
    v_cvt_pk_bf16_f32 v180, v184, v185
    v_cvt_pk_bf16_f32 v181, v186, v187
    v_cvt_pk_bf16_f32 v182, v188, v189
    v_cvt_pk_bf16_f32 v183, v190, v191
    v_pk_max_i16 v180, v180, 0
    v_pk_max_i16 v181, v181, 0
    v_pk_max_i16 v182, v182, 0
    v_pk_max_i16 v183, v183, 0
    buffer_store_dwordx4 v[176:179], v1, s[56:59], s75 offen offset:0 sc1
    buffer_store_dwordx4 v[180:183], v1, s[56:59], s75 offen offset:1024 sc1
    s_lshl_b32 s78, s63, 2
    s_add_u32 s78, s78, s64
    s_lshl_b32 s78, s78, 2
    s_add_u32 s78, s78, 0x1f000
    v_mov_b32 v9, s65
    s_mov_b64 exec, 1
    s_waitcnt vmcnt(0)
    s_cmp_eq_u32 s66, 0
    s_cbranch_scc1 imp_37
    buffer_store_dword v9, off, s[56:59], s78 offset:768
    s_branch join_38
imp_37:
    buffer_store_dword v9, off, s[56:59], s78 offset:768 sc1
join_38:
    s_mov_b64 exec, -1
    ds_read_b64_tr_b16 a[136:137], v2 offset:0
    ds_read_b64_tr_b16 a[140:141], v3 offset:0
    ds_read_b64_tr_b16 a[138:139], v2 offset:1024
    ds_read_b64_tr_b16 a[142:143], v3 offset:1024
    ds_read_b64_tr_b16 a[144:145], v2 offset:2048
    ds_read_b64_tr_b16 a[148:149], v3 offset:2048
    ds_read_b64_tr_b16 a[146:147], v2 offset:3072
    ds_read_b64_tr_b16 a[150:151], v3 offset:3072
    ds_read_b64_tr_b16 a[152:153], v2 offset:4096
    ds_read_b64_tr_b16 a[156:157], v3 offset:4096
    ds_read_b64_tr_b16 a[154:155], v2 offset:5120
    ds_read_b64_tr_b16 a[158:159], v3 offset:5120
    ds_read_b64_tr_b16 a[160:161], v2 offset:6144
    ds_read_b64_tr_b16 a[164:165], v3 offset:6144
    ds_read_b64_tr_b16 a[162:163], v2 offset:7168
    ds_read_b64_tr_b16 a[166:167], v3 offset:7168
    ds_read_b64_tr_b16 a[168:169], v2 offset:8192
    ds_read_b64_tr_b16 a[172:173], v3 offset:8192
    ds_read_b64_tr_b16 a[170:171], v2 offset:9216
    ds_read_b64_tr_b16 a[174:175], v3 offset:9216
    ds_read_b64_tr_b16 a[176:177], v2 offset:10240
    ds_read_b64_tr_b16 a[180:181], v3 offset:10240
    ds_read_b64_tr_b16 a[178:179], v2 offset:11264
    ds_read_b64_tr_b16 a[182:183], v3 offset:11264
    ds_read_b64_tr_b16 a[184:185], v2 offset:12288
    ds_read_b64_tr_b16 a[188:189], v3 offset:12288
    ds_read_b64_tr_b16 a[186:187], v2 offset:13312
    ds_read_b64_tr_b16 a[190:191], v3 offset:13312
    ds_read_b64_tr_b16 a[192:193], v2 offset:14336
    ds_read_b64_tr_b16 a[196:197], v3 offset:14336
    s_waitcnt lgkmcnt(0)
    s_add_u32 m0, s68, 0x0
    s_add_u32 s79, s13, 0x42000
    buffer_load_dwordx4 v4, s[44:47], s79 offen lds
    s_add_u32 m0, s68, 0x400
    s_add_u32 s79, s13, 0x44000
    buffer_load_dwordx4 v4, s[44:47], s79 offen lds
    s_add_u32 m0, s68, 0x800
    s_add_u32 s79, s13, 0x46000
    buffer_load_dwordx4 v4, s[44:47], s79 offen lds
    s_add_u32 m0, s68, 0xc00
    s_add_u32 s79, s13, 0x48000
    buffer_load_dwordx4 v4, s[44:47], s79 offen lds
    s_add_u32 m0, s68, 0x1000
    s_add_u32 s79, s13, 0x4a000
    buffer_load_dwordx4 v4, s[44:47], s79 offen lds
    s_add_u32 m0, s68, 0x1400
    s_add_u32 s79, s13, 0x4c000
    buffer_load_dwordx4 v4, s[44:47], s79 offen lds
    s_add_u32 m0, s68, 0x1800
    s_add_u32 s79, s13, 0x4e000
    buffer_load_dwordx4 v4, s[44:47], s79 offen lds
    s_add_u32 m0, s68, 0x1c00
    s_add_u32 s79, s13, 0x50000
    buffer_load_dwordx4 v4, s[44:47], s79 offen lds
    s_add_u32 m0, s68, 0x2000
    s_add_u32 s79, s13, 0x52000
    buffer_load_dwordx4 v4, s[44:47], s79 offen lds
    s_add_u32 m0, s68, 0x2400
    s_add_u32 s79, s13, 0x54000
    buffer_load_dwordx4 v4, s[44:47], s79 offen lds
    s_add_u32 m0, s68, 0x2800
    s_add_u32 s79, s13, 0x56000
    buffer_load_dwordx4 v4, s[44:47], s79 offen lds
    v_bfe_u32 v6, v0, 1, 4
    v_and_b32 v7, 1, v0
    v_lshl_add_u32 v6, v6, 2, v7
    s_and_b32 s76, s6, 2
    v_add_lshl_u32 v6, v6, s76, 2
    s_mul_i32 s75, s64, 22
    s_lshl_b32 s73, s6, 7
    s_add_u32 s73, s73, s75
    s_lshl_b32 s73, s73, 10
    s_xor_b32 s74, s73, 0x20000
    s_mov_b32 s48, s22
    s_mov_b32 s49, s23
    s_mov_b32 s50, 0x200000
    s_mov_b32 s51, 0x00020000
    s_mov_b32 s78, 0x1f300
    buffer_load_dword v230, v6, s[56:59], s78 offen sc1
poll_H_39:
    s_waitcnt vmcnt(0)
    v_cmp_ne_u32 vcc, s65, v230
    s_cbranch_vccz done_H_40
    buffer_load_dword v230, v6, s[56:59], s78 offen sc1
    s_sub_u32 s67, s67, 1
    s_cbranch_scc0 poll_H_39
    s_endpgm
done_H_40:
    s_add_u32 s77, s74, 0x8000
    buffer_load_dwordx4 v[16:19], v1, s[56:59], s77 offen offset:0 sc1
    buffer_load_dwordx4 v[20:23], v1, s[56:59], s77 offen offset:1024 sc1
    buffer_load_dwordx4 v[24:27], v1, s[56:59], s77 offen offset:2048 sc1
    buffer_load_dwordx4 v[28:31], v1, s[56:59], s77 offen offset:3072 sc1
    s_add_u32 s77, s74, 0x9000
    buffer_load_dwordx4 v[32:35], v1, s[56:59], s77 offen offset:0 sc1
    buffer_load_dwordx4 v[36:39], v1, s[56:59], s77 offen offset:1024 sc1
    buffer_load_dwordx4 v[40:43], v1, s[56:59], s77 offen offset:2048 sc1
    buffer_load_dwordx4 v[44:47], v1, s[56:59], s77 offen offset:3072 sc1
    s_add_u32 s77, s74, 0xa000
    buffer_load_dwordx4 v[48:51], v1, s[56:59], s77 offen offset:0 sc1
    buffer_load_dwordx4 v[52:55], v1, s[56:59], s77 offen offset:1024 sc1
    buffer_load_dwordx4 v[56:59], v1, s[56:59], s77 offen offset:2048 sc1
    buffer_load_dwordx4 v[60:63], v1, s[56:59], s77 offen offset:3072 sc1
    ds_read_b64_tr_b16 a[194:195], v2 offset:0
    ds_read_b64_tr_b16 a[198:199], v3 offset:0
    ds_read_b64_tr_b16 a[200:201], v2 offset:1024
    ds_read_b64_tr_b16 a[204:205], v3 offset:1024
    ds_read_b64_tr_b16 a[202:203], v2 offset:2048
    ds_read_b64_tr_b16 a[206:207], v3 offset:2048
    ds_read_b64_tr_b16 a[208:209], v2 offset:3072
    ds_read_b64_tr_b16 a[212:213], v3 offset:3072
    ds_read_b64_tr_b16 a[210:211], v2 offset:4096
    ds_read_b64_tr_b16 a[214:215], v3 offset:4096
    ds_read_b64_tr_b16 a[216:217], v2 offset:5120
    ds_read_b64_tr_b16 a[220:221], v3 offset:5120
    ds_read_b64_tr_b16 a[218:219], v2 offset:6144
    ds_read_b64_tr_b16 a[222:223], v3 offset:6144
    ds_read_b64_tr_b16 a[224:225], v2 offset:7168
    ds_read_b64_tr_b16 a[228:229], v3 offset:7168
    ds_read_b64_tr_b16 a[226:227], v2 offset:8192
    ds_read_b64_tr_b16 a[230:231], v3 offset:8192
    ds_read_b64_tr_b16 a[232:233], v2 offset:9216
    ds_read_b64_tr_b16 a[236:237], v3 offset:9216
    ds_read_b64_tr_b16 a[234:235], v2 offset:10240
    ds_read_b64_tr_b16 a[238:239], v3 offset:10240
    v_add_u32 v12, s68, v1
    s_waitcnt vmcnt(11)
    v_mfma_f32_32x32x16_bf16 a[16:31], a[64:67], v[16:19], 0
    v_mfma_f32_32x32x16_bf16 a[48:63], a[68:71], v[16:19], 0
    s_add_u32 s77, s74, 0xb000
    buffer_load_dwordx4 v[64:67], v1, s[56:59], s77 offen offset:0 sc1
    s_waitcnt vmcnt(11)
    v_mfma_f32_32x32x16_bf16 a[16:31], a[72:75], v[20:23], a[16:31]
    v_mfma_f32_32x32x16_bf16 a[48:63], a[76:79], v[20:23], a[48:63]
    buffer_load_dwordx4 v[68:71], v1, s[56:59], s77 offen offset:1024 sc1
    s_waitcnt vmcnt(11)
    v_mfma_f32_32x32x16_bf16 a[16:31], a[80:83], v[24:27], a[16:31]
    v_mfma_f32_32x32x16_bf16 a[48:63], a[84:87], v[24:27], a[48:63]
    buffer_load_dwordx4 v[72:75], v1, s[56:59], s77 offen offset:2048 sc1
    s_waitcnt vmcnt(11)
    v_mfma_f32_32x32x16_bf16 a[16:31], a[88:91], v[28:31], a[16:31]
    v_mfma_f32_32x32x16_bf16 a[48:63], a[92:95], v[28:31], a[48:63]
    buffer_load_dwordx4 v[76:79], v1, s[56:59], s77 offen offset:3072 sc1
    s_waitcnt vmcnt(11)
    v_mfma_f32_32x32x16_bf16 a[16:31], a[96:99], v[32:35], a[16:31]
    v_mfma_f32_32x32x16_bf16 a[48:63], a[100:103], v[32:35], a[48:63]
    s_add_u32 s77, s74, 0xc000
    buffer_load_dwordx4 v[80:83], v1, s[56:59], s77 offen offset:0 sc1
    s_waitcnt vmcnt(11)
    v_mfma_f32_32x32x16_bf16 a[16:31], a[104:107], v[36:39], a[16:31]
    v_mfma_f32_32x32x16_bf16 a[48:63], a[108:111], v[36:39], a[48:63]
    buffer_load_dwordx4 v[84:87], v1, s[56:59], s77 offen offset:1024 sc1
    s_waitcnt vmcnt(11)
    v_mfma_f32_32x32x16_bf16 a[16:31], a[112:115], v[40:43], a[16:31]
    v_mfma_f32_32x32x16_bf16 a[48:63], a[116:119], v[40:43], a[48:63]
    buffer_load_dwordx4 v[88:91], v1, s[56:59], s77 offen offset:2048 sc1
    s_waitcnt vmcnt(11)
    v_mfma_f32_32x32x16_bf16 a[16:31], a[120:123], v[44:47], a[16:31]
    v_mfma_f32_32x32x16_bf16 a[48:63], a[124:127], v[44:47], a[48:63]
    buffer_load_dwordx4 v[92:95], v1, s[56:59], s77 offen offset:3072 sc1
    s_waitcnt vmcnt(11)
    s_waitcnt lgkmcnt(0)
    v_mfma_f32_32x32x16_bf16 a[16:31], a[128:131], v[48:51], a[16:31]
    v_mfma_f32_32x32x16_bf16 a[48:63], a[132:135], v[48:51], a[48:63]
    s_add_u32 s77, s74, 0xd000
    buffer_load_dwordx4 v[96:99], v1, s[56:59], s77 offen offset:0 sc1
    s_waitcnt vmcnt(11)
    v_mfma_f32_32x32x16_bf16 a[16:31], a[136:139], v[52:55], a[16:31]
    v_mfma_f32_32x32x16_bf16 a[48:63], a[140:143], v[52:55], a[48:63]
    buffer_load_dwordx4 v[100:103], v1, s[56:59], s77 offen offset:1024 sc1
    s_waitcnt vmcnt(11)
    v_mfma_f32_32x32x16_bf16 a[16:31], a[144:147], v[56:59], a[16:31]
    v_mfma_f32_32x32x16_bf16 a[48:63], a[148:151], v[56:59], a[48:63]
    s_add_u32 s77, s73, 0x8000
    buffer_load_dwordx4 v[104:107], v1, s[56:59], s77 offen offset:0 sc1
    s_waitcnt vmcnt(11)
    v_mfma_f32_32x32x16_bf16 a[16:31], a[152:155], v[60:63], a[16:31]
    v_mfma_f32_32x32x16_bf16 a[48:63], a[156:159], v[60:63], a[48:63]
    buffer_load_dwordx4 v[108:111], v1, s[56:59], s77 offen offset:1024 sc1
    s_waitcnt vmcnt(11)
    v_mfma_f32_32x32x16_bf16 a[16:31], a[160:163], v[64:67], a[16:31]
    v_mfma_f32_32x32x16_bf16 a[48:63], a[164:167], v[64:67], a[48:63]
    buffer_load_dwordx4 v[112:115], v1, s[56:59], s77 offen offset:2048 sc1
    s_waitcnt vmcnt(11)
    v_mfma_f32_32x32x16_bf16 a[16:31], a[168:171], v[68:71], a[16:31]
    v_mfma_f32_32x32x16_bf16 a[48:63], a[172:175], v[68:71], a[48:63]
    buffer_load_dwordx4 v[116:119], v1, s[56:59], s77 offen offset:3072 sc1
    s_waitcnt vmcnt(11)
    v_mfma_f32_32x32x16_bf16 a[16:31], a[176:179], v[72:75], a[16:31]
    v_mfma_f32_32x32x16_bf16 a[48:63], a[180:183], v[72:75], a[48:63]
    s_add_u32 s77, s73, 0x9000
    buffer_load_dwordx4 v[120:123], v1, s[56:59], s77 offen offset:0 sc1
    s_waitcnt vmcnt(11)
    v_mfma_f32_32x32x16_bf16 a[16:31], a[184:187], v[76:79], a[16:31]
    v_mfma_f32_32x32x16_bf16 a[48:63], a[188:191], v[76:79], a[48:63]
    buffer_load_dwordx4 v[124:127], v1, s[56:59], s77 offen offset:1024 sc1
    s_waitcnt vmcnt(11)
    v_mfma_f32_32x32x16_bf16 a[16:31], a[192:195], v[80:83], a[16:31]
    v_mfma_f32_32x32x16_bf16 a[48:63], a[196:199], v[80:83], a[48:63]
    buffer_load_dwordx4 v[128:131], v1, s[56:59], s77 offen offset:2048 sc1
    s_waitcnt vmcnt(11)
    v_mfma_f32_32x32x16_bf16 a[16:31], a[200:203], v[84:87], a[16:31]
    v_mfma_f32_32x32x16_bf16 a[48:63], a[204:207], v[84:87], a[48:63]
    buffer_load_dwordx4 v[132:135], v1, s[56:59], s77 offen offset:3072 sc1
    s_waitcnt vmcnt(11)
    v_mfma_f32_32x32x16_bf16 a[16:31], a[208:211], v[88:91], a[16:31]
    v_mfma_f32_32x32x16_bf16 a[48:63], a[212:215], v[88:91], a[48:63]
    s_add_u32 s77, s73, 0xa000
    buffer_load_dwordx4 v[136:139], v1, s[56:59], s77 offen offset:0 sc1
    s_waitcnt vmcnt(11)
    v_mfma_f32_32x32x16_bf16 a[16:31], a[216:219], v[92:95], a[16:31]
    v_mfma_f32_32x32x16_bf16 a[48:63], a[220:223], v[92:95], a[48:63]
    buffer_load_dwordx4 v[140:143], v1, s[56:59], s77 offen offset:1024 sc1
    buffer_load_dwordx4 v[144:147], v1, s[56:59], s77 offen offset:2048 sc1
    buffer_load_dwordx4 v[148:151], v1, s[56:59], s77 offen offset:3072 sc1
    s_waitcnt vmcnt(12)
    s_cmp_eq_u32 s64, 3
    s_cbranch_scc1 w3_41
    v_mfma_f32_32x32x16_bf16 a[16:31], a[224:227], v[96:99], a[16:31]
    v_mfma_f32_32x32x16_bf16 a[48:63], a[228:231], v[96:99], a[48:63]
    v_mfma_f32_32x32x16_bf16 a[16:31], a[232:235], v[100:103], a[16:31]
    v_mfma_f32_32x32x16_bf16 a[48:63], a[236:239], v[100:103], a[48:63]
w3_41:
    s_waitcnt vmcnt(11)
    v_mfma_f32_32x32x16_bf16 a[32:47], a[68:71], v[104:107], 0
    s_add_u32 s77, s73, 0xb000
    buffer_load_dwordx4 v[152:155], v1, s[56:59], s77 offen offset:0 sc1
    s_waitcnt vmcnt(11)
    v_mfma_f32_32x32x16_bf16 a[32:47], a[76:79], v[108:111], a[32:47]
    buffer_load_dwordx4 v[156:159], v1, s[56:59], s77 offen offset:1024 sc1
    s_nop 3
    ds_write_b128 v12, a[16:19] offset:0
    s_waitcnt vmcnt(11)
    v_mfma_f32_32x32x16_bf16 a[32:47], a[84:87], v[112:115], a[32:47]
    buffer_load_dwordx4 v[160:163], v1, s[56:59], s77 offen offset:2048 sc1
    ds_write_b128 v12, a[20:23] offset:1024
    s_waitcnt vmcnt(11)
    v_mfma_f32_32x32x16_bf16 a[32:47], a[92:95], v[116:119], a[32:47]
    buffer_load_dwordx4 v[164:167], v1, s[56:59], s77 offen offset:3072 sc1
    ds_write_b128 v12, a[24:27] offset:2048
    s_waitcnt vmcnt(11)
    v_mfma_f32_32x32x16_bf16 a[32:47], a[100:103], v[120:123], a[32:47]
    s_add_u32 s77, s73, 0xc000
    buffer_load_dwordx4 v[168:171], v1, s[56:59], s77 offen offset:0 sc1
    ds_write_b128 v12, a[28:31] offset:3072
    s_waitcnt vmcnt(11)
    v_mfma_f32_32x32x16_bf16 a[32:47], a[108:111], v[124:127], a[32:47]
    buffer_load_dwordx4 v[172:175], v1, s[56:59], s77 offen offset:1024 sc1
    ds_write_b128 v12, a[48:51] offset:8192
    s_waitcnt vmcnt(11)
    v_mfma_f32_32x32x16_bf16 a[32:47], a[116:119], v[128:131], a[32:47]
    buffer_load_dwordx4 v[176:179], v1, s[56:59], s77 offen offset:2048 sc1
    v_mfma_f32_32x32x16_bf16 a[0:15], a[64:67], v[104:107], 0
    ds_write_b128 v12, a[52:55] offset:9216
    s_waitcnt vmcnt(11)
    v_mfma_f32_32x32x16_bf16 a[32:47], a[124:127], v[132:135], a[32:47]
    buffer_load_dwordx4 v[180:183], v1, s[56:59], s77 offen offset:3072 sc1
    v_mfma_f32_32x32x16_bf16 a[0:15], a[72:75], v[108:111], a[0:15]
    ds_write_b128 v12, a[56:59] offset:10240
    s_waitcnt vmcnt(11)
    v_mfma_f32_32x32x16_bf16 a[32:47], a[132:135], v[136:139], a[32:47]
    s_add_u32 s77, s73, 0xd000
    buffer_load_dwordx4 v[184:187], v1, s[56:59], s77 offen offset:0 sc1
    v_mfma_f32_32x32x16_bf16 a[0:15], a[80:83], v[112:115], a[0:15]
    ds_write_b128 v12, a[60:63] offset:11264
    s_waitcnt vmcnt(11)
    v_mfma_f32_32x32x16_bf16 a[32:47], a[140:143], v[140:143], a[32:47]
    buffer_load_dwordx4 v[188:191], v1, s[56:59], s77 offen offset:1024 sc1
    v_mfma_f32_32x32x16_bf16 a[0:15], a[88:91], v[116:119], a[0:15]
    s_waitcnt vmcnt(11)
    v_mfma_f32_32x32x16_bf16 a[32:47], a[148:151], v[144:147], a[32:47]
    v_mfma_f32_32x32x16_bf16 a[0:15], a[96:99], v[120:123], a[0:15]
    s_waitcnt vmcnt(10)
    v_mfma_f32_32x32x16_bf16 a[32:47], a[156:159], v[148:151], a[32:47]
    v_mfma_f32_32x32x16_bf16 a[0:15], a[104:107], v[124:127], a[0:15]
    s_waitcnt vmcnt(9)
    v_mfma_f32_32x32x16_bf16 a[32:47], a[164:167], v[152:155], a[32:47]
    v_mfma_f32_32x32x16_bf16 a[0:15], a[112:115], v[128:131], a[0:15]
    s_waitcnt vmcnt(8)
    v_mfma_f32_32x32x16_bf16 a[32:47], a[172:175], v[156:159], a[32:47]
    v_mfma_f32_32x32x16_bf16 a[0:15], a[120:123], v[132:135], a[0:15]
    s_waitcnt vmcnt(7)
    v_mfma_f32_32x32x16_bf16 a[32:47], a[180:183], v[160:163], a[32:47]
    v_mfma_f32_32x32x16_bf16 a[0:15], a[128:131], v[136:139], a[0:15]
    s_waitcnt vmcnt(6)
    v_mfma_f32_32x32x16_bf16 a[32:47], a[188:191], v[164:167], a[32:47]
    v_mfma_f32_32x32x16_bf16 a[0:15], a[136:139], v[140:143], a[0:15]
    s_waitcnt vmcnt(5)
    v_mfma_f32_32x32x16_bf16 a[32:47], a[196:199], v[168:171], a[32:47]
    v_mfma_f32_32x32x16_bf16 a[0:15], a[144:147], v[144:147], a[0:15]
    s_waitcnt vmcnt(4)
    v_mfma_f32_32x32x16_bf16 a[32:47], a[204:207], v[172:175], a[32:47]
    v_mfma_f32_32x32x16_bf16 a[0:15], a[152:155], v[148:151], a[0:15]
    s_waitcnt vmcnt(3)
    v_mfma_f32_32x32x16_bf16 a[32:47], a[212:215], v[176:179], a[32:47]
    v_mfma_f32_32x32x16_bf16 a[0:15], a[160:163], v[152:155], a[0:15]
    s_waitcnt vmcnt(2)
    v_mfma_f32_32x32x16_bf16 a[32:47], a[220:223], v[180:183], a[32:47]
    v_mfma_f32_32x32x16_bf16 a[0:15], a[168:171], v[156:159], a[0:15]
    s_waitcnt vmcnt(0)
    s_cmp_eq_u32 s64, 3
    s_cbranch_scc1 w3_42
    v_mfma_f32_32x32x16_bf16 a[32:47], a[228:231], v[184:187], a[32:47]
    v_mfma_f32_32x32x16_bf16 a[32:47], a[236:239], v[188:191], a[32:47]
    v_mfma_f32_32x32x16_bf16 a[0:15], a[224:227], v[184:187], a[0:15]
    v_mfma_f32_32x32x16_bf16 a[0:15], a[232:235], v[188:191], a[0:15]
w3_42:
    v_mfma_f32_32x32x16_bf16 a[0:15], a[176:179], v[160:163], a[0:15]
    v_mfma_f32_32x32x16_bf16 a[0:15], a[184:187], v[164:167], a[0:15]
    v_mfma_f32_32x32x16_bf16 a[0:15], a[192:195], v[168:171], a[0:15]
    s_nop 6
    ds_write_b128 v12, a[32:35] offset:4096
    v_mfma_f32_32x32x16_bf16 a[0:15], a[200:203], v[172:175], a[0:15]
    ds_write_b128 v12, a[36:39] offset:5120
    v_mfma_f32_32x32x16_bf16 a[0:15], a[208:211], v[176:179], a[0:15]
    ds_write_b128 v12, a[40:43] offset:6144
    v_mfma_f32_32x32x16_bf16 a[0:15], a[216:219], v[180:183], a[0:15]
    ds_write_b128 v12, a[44:47] offset:7168
    v_xor_b32 v6, 0x4000, v12
    v_xor_b32 v7, 0x8000, v12
    v_xor_b32 v8, 0xc000, v12
    v_and_b32 v9, 31, v0
    s_lshl_b32 s75, s6, 14
    s_add_u32 s75, s75, 0x3f00
    v_lshl_add_u32 v9, v9, 2, s75
    v_add_u32 v14, s68, v14
    v_xor_b32 v115, 16, v14
    v_xor_b32 v116, 32, v14
    v_xor_b32 v117, 48, v14
    s_add_u32 s76, s7, 16384
    v_accvgpr_read_b32 v96, a240
    v_accvgpr_read_b32 v97, a241
    v_accvgpr_read_b32 v98, a242
    v_accvgpr_read_b32 v99, a243
    v_accvgpr_read_b32 v100, a244
    v_accvgpr_read_b32 v101, a245
    v_accvgpr_read_b32 v102, a246
    v_accvgpr_read_b32 v103, a247
    v_accvgpr_read_b32 v104, a248
    v_accvgpr_read_b32 v105, a249
    v_accvgpr_read_b32 v106, a250
    v_accvgpr_read_b32 v107, a251
    v_accvgpr_read_b32 v108, a252
    v_accvgpr_read_b32 v109, a253
    v_accvgpr_read_b32 v110, a254
    v_accvgpr_read_b32 v111, a255
    s_waitcnt lgkmcnt(0)
    s_barrier
    ds_read_b32 v112, v9
    v_accvgpr_read_b32 v16, a0
    v_accvgpr_read_b32 v17, a1
    v_accvgpr_read_b32 v18, a2
    v_accvgpr_read_b32 v19, a3
    v_accvgpr_read_b32 v20, a4
    v_accvgpr_read_b32 v21, a5
    v_accvgpr_read_b32 v22, a6
    v_accvgpr_read_b32 v23, a7
    v_accvgpr_read_b32 v24, a8
    v_accvgpr_read_b32 v25, a9
    v_accvgpr_read_b32 v26, a10
    v_accvgpr_read_b32 v27, a11
    v_accvgpr_read_b32 v28, a12
    v_accvgpr_read_b32 v29, a13
    v_accvgpr_read_b32 v30, a14
    v_accvgpr_read_b32 v31, a15
    ds_read_b128 v[32:35], v6 offset:0
    ds_read_b128 v[36:39], v6 offset:1024
    ds_read_b128 v[40:43], v6 offset:2048
    ds_read_b128 v[44:47], v6 offset:3072
    ds_read_b128 v[48:51], v7 offset:4096
    ds_read_b128 v[52:55], v7 offset:5120
    ds_read_b128 v[56:59], v7 offset:6144
    ds_read_b128 v[60:63], v7 offset:7168
    ds_read_b128 v[64:67], v8 offset:8192
    ds_read_b128 v[68:71], v8 offset:9216
    ds_read_b128 v[72:75], v8 offset:10240
    ds_read_b128 v[76:79], v8 offset:11264
    s_waitcnt lgkmcnt(8)
    v_pk_add_f32 v[16:17], v[16:17], v[32:33]
    v_pk_add_f32 v[18:19], v[18:19], v[34:35]
    v_pk_add_f32 v[20:21], v[20:21], v[36:37]
    v_pk_add_f32 v[22:23], v[22:23], v[38:39]
    v_pk_add_f32 v[24:25], v[24:25], v[40:41]
    v_pk_add_f32 v[26:27], v[26:27], v[42:43]
    v_pk_add_f32 v[28:29], v[28:29], v[44:45]
    v_pk_add_f32 v[30:31], v[30:31], v[46:47]
    s_waitcnt lgkmcnt(4)
    v_pk_add_f32 v[16:17], v[16:17], v[48:49]
    v_pk_add_f32 v[18:19], v[18:19], v[50:51]
    v_pk_add_f32 v[20:21], v[20:21], v[52:53]
    v_pk_add_f32 v[22:23], v[22:23], v[54:55]
    v_pk_add_f32 v[24:25], v[24:25], v[56:57]
    v_pk_add_f32 v[26:27], v[26:27], v[58:59]
    v_pk_add_f32 v[28:29], v[28:29], v[60:61]
    v_pk_add_f32 v[30:31], v[30:31], v[62:63]
    s_waitcnt lgkmcnt(0)
    v_pk_add_f32 v[16:17], v[16:17], v[64:65]
    v_pk_add_f32 v[18:19], v[18:19], v[66:67]
    v_pk_add_f32 v[20:21], v[20:21], v[68:69]
    v_pk_add_f32 v[22:23], v[22:23], v[70:71]
    v_pk_add_f32 v[24:25], v[24:25], v[72:73]
    v_pk_add_f32 v[26:27], v[26:27], v[74:75]
    v_pk_add_f32 v[28:29], v[28:29], v[76:77]
    v_pk_add_f32 v[30:31], v[30:31], v[78:79]
    v_pk_mul_f32 v[240:241], v[240:241], v[112:113] op_sel_hi:[1,0]
    v_pk_mul_f32 v[242:243], v[242:243], v[112:113] op_sel_hi:[1,0]
    v_pk_mul_f32 v[244:245], v[244:245], v[112:113] op_sel_hi:[1,0]
    v_pk_mul_f32 v[246:247], v[246:247], v[112:113] op_sel_hi:[1,0]
    v_pk_mul_f32 v[248:249], v[248:249], v[112:113] op_sel_hi:[1,0]
    v_pk_mul_f32 v[250:251], v[250:251], v[112:113] op_sel_hi:[1,0]
    v_pk_mul_f32 v[252:253], v[252:253], v[112:113] op_sel_hi:[1,0]
    v_pk_mul_f32 v[254:255], v[254:255], v[112:113] op_sel_hi:[1,0]
    v_pk_fma_f32 v[16:17], v[16:17], v[240:241], v[96:97]
    v_pk_fma_f32 v[18:19], v[18:19], v[242:243], v[98:99]
    v_pk_fma_f32 v[20:21], v[20:21], v[244:245], v[100:101]
    v_pk_fma_f32 v[22:23], v[22:23], v[246:247], v[102:103]
    v_pk_fma_f32 v[24:25], v[24:25], v[248:249], v[104:105]
    v_pk_fma_f32 v[26:27], v[26:27], v[250:251], v[106:107]
    v_pk_fma_f32 v[28:29], v[28:29], v[252:253], v[108:109]
    v_pk_fma_f32 v[30:31], v[30:31], v[254:255], v[110:111]
    v_cvt_pk_bf16_f32 v96, v16, v17
    v_cvt_pk_bf16_f32 v97, v18, v19
    ds_write_b64 v14, v[96:97] offset:12288
    v_cvt_pk_bf16_f32 v98, v20, v21
    v_cvt_pk_bf16_f32 v99, v22, v23
    ds_write_b64 v115, v[98:99] offset:12288
    v_cvt_pk_bf16_f32 v100, v24, v25
    v_cvt_pk_bf16_f32 v101, v26, v27
    ds_write_b64 v116, v[100:101] offset:12288
    v_cvt_pk_bf16_f32 v102, v28, v29
    v_cvt_pk_bf16_f32 v103, v30, v31
    ds_write_b64 v117, v[102:103] offset:12288
    ds_read_b128 v[16:19], v12 offset:12288
    ds_read_b128 v[20:23], v12 offset:13312
    s_waitcnt lgkmcnt(1)
    buffer_store_dwordx4 v[16:19], v13, s[48:51], s7 offen
    s_waitcnt lgkmcnt(0)
    buffer_store_dwordx4 v[20:23], v13, s[48:51], s76 offen
    s_or_b32 s72, s2, s64
    s_cmp_lg_u32 s72, 0
    s_cbranch_scc1 end_43
    v_mov_b32 v6, s65
    buffer_store_dword v6, off, s[52:55], 0 sc1
end_43:
L_last:
    s_endpgm
.section .rodata,"a"
.p2align 6
.amdhsa_kernel adaLN_cond__linear_kernel_hedgehog__dense_activation_relu__prompt_kernel
  .amdhsa_next_free_vgpr 512
  .amdhsa_next_free_sgpr 102
  .amdhsa_accum_offset 256
  .amdhsa_group_segment_fixed_size 0
  .amdhsa_kernarg_size 96
  .amdhsa_user_sgpr_count 2
  .amdhsa_user_sgpr_kernarg_segment_ptr 1
  .amdhsa_system_sgpr_workgroup_id_x 1
.end_amdhsa_kernel
```
